```python
import torch

def _softmax(x, axis=-1):
    return torch.softmax(x, dim=axis)
def _gelu(x):
    return torch.nn.functional.gelu(x, approximate="tanh")
def _silu(x):
    return torch.nn.functional.silu(x)
def _sigmoid(x):
    return torch.sigmoid(x)
def _layernorm(x, axis=-1, eps=1e-5):
    m = x.mean(dim=axis, keepdim=True)
    v = x.var(dim=axis, keepdim=True, unbiased=False)
    return (x - m) / torch.sqrt(v + eps)
def _scatter_add(tgt, idx, src, axis=0):
    return tgt.clone().index_add_(axis, idx, src)
def _segment_sum(src, seg, n):
    out = torch.zeros((n,) + src.shape[1:], dtype=src.dtype)
    return out.index_add_(0, seg, src)
def _pad(x, pw):
    flat = tuple(v for pair in reversed(pw) for v in pair)
    return torch.nn.functional.pad(x, flat)

kernel_name = 'recurrent_scan__gqa_block_cached__dense_activation_relu__decode'

def setup_inputs():

    _w = (lambda a: (lambda t: t.to(torch.bfloat16) if t.is_floating_point() else t)(torch.as_tensor(a)))
    def _A_setup():
        B, Sq, D = 1, 1, 512
        Hq, Hkv, Sk, Dh = 32, 32, 32768, 128
        assert Hq % Hkv == 0, (Hq, Hkv)
        return {
            "x": _w((lambda *s: torch.randn(*s, dtype=torch.bfloat16) * 0.05)(B, Sq, D)),
            "k_cache": _w((lambda *s: torch.randn(*s, dtype=torch.bfloat16) * 0.8)(B, Hkv, Sk, Dh)),
            "v_cache": _w((lambda *s: torch.randn(*s, dtype=torch.bfloat16) * 0.8)(B, Hkv, Sk, Dh)),
            "wq": _w((lambda *s: torch.randn(*s, dtype=torch.bfloat16) * 0.8)(D, Hq * Dh) * (D ** -0.5)),
            "wo": _w((lambda *s: torch.randn(*s, dtype=torch.bfloat16) * 0.8)(Hq * Dh, D) * ((Hq * Dh) ** -0.5)),
        }
    _A_in = _A_setup()

    def _B_setup():
        B, S, D, Dff = 1, 1, 512, 1376
        return {
            "x": _w((lambda *s: torch.randn(*s, dtype=torch.bfloat16) * 0.05)(B, S, D)),
            "w1": _w((lambda *s: torch.randn(*s, dtype=torch.bfloat16) * 0.2)(D, Dff)),
            "w2": _w((lambda *s: torch.randn(*s, dtype=torch.bfloat16) * 0.2)(Dff, D)),
        }
    _B_in = _B_setup()

    return {
        "A_x": _A_in["x"],
        "A_k_cache": _A_in["k_cache"],
        "A_v_cache": _A_in["v_cache"],
        "A_wq": _A_in["wq"],
        "A_wo": _A_in["wo"],
        "B_x": _B_in["x"],
        "B_w1": _B_in["w1"],
        "B_w2": _B_in["w2"],
    }

def reference(A_x, A_k_cache, A_v_cache, A_wq, A_wo, B_x, B_w1, B_w2):
    def _A_ref(x, k_cache, v_cache, wq, wo):
        B, Sq, D = x.shape
        Hq, Dh = 32, 128
        Hkv = k_cache.shape[1]
        rep = Hq // Hkv
        q = (lambda x, *d: x.permute(*d))((x @ wq).reshape(B, Sq, Hq, Dh), 0, 2, 1, 3)
        k = (lambda x, n, axis: torch.repeat_interleave(x, n, dim=axis))(k_cache, rep, axis=1)
        v = (lambda x, n, axis: torch.repeat_interleave(x, n, dim=axis))(v_cache, rep, axis=1)
        scores = torch.einsum("bhqd,bhkd->bhqk", q, k) * (Dh ** -0.5)
        p = _softmax(scores, axis=-1)
        o = torch.einsum("bhqk,bhkd->bhqd", p, v)
        return (lambda x, *d: x.permute(*d))(o, 0, 2, 1, 3).reshape(B, Sq, Hq * Dh) @ wo

    def _B_ref(x, w1, w2):
        h = torch.einsum("bsd,df->bsf", x, w1)
        zero = torch.zeros_like(h)
        h = torch.maximum(h, zero)
        return torch.einsum("bsf,fd->bsd", h, w2)

    x = A_x
    xn = _layernorm(x, axis=-1)
    s = _A_ref(xn, A_k_cache, A_v_cache, A_wq, A_wo)
    g = _silu(_B_ref(xn, B_w1, B_w2))
    return x + s * g
```

```asm
; @launch grid=(256,1,1) block=(320,1,1) lds=86016
.amdgcn_target "amdgcn-amd-amdhsa--gfx950"
.text
.globl recurrent_scan__gqa_block_cached__dense_activation_relu__decode_kernel
.p2align 8
.type recurrent_scan__gqa_block_cached__dense_activation_relu__decode_kernel,@function
recurrent_scan__gqa_block_cached__dense_activation_relu__decode_kernel:
  s_cmp_ge_u32 s2, 256
  s_cbranch_scc1 L_end
  s_load_dwordx16 s[36:51], s[0:1], 0
  s_load_dwordx2 s[52:53], s[0:1], 64
  s_load_dwordx2 s[56:57], s[0:1], 80
  v_lshrrev_b32 v1, 6, v0
  s_lshr_b32 s4, s2, 3
  s_and_b32 s5, s2, 7
  v_readfirstlane_b32 s3, v1
  v_and_b32 v2, 63, v0
  v_lshlrev_b32 v1, 4, v2
  s_mov_b32 s16, 0x3e0293ee
  s_mul_i32 s34, s4, 36864
  s_lshl_b32 s32, s4, 23
  s_bfe_u32 s58, s5, 196608
  s_lshl_b32 s58, s58, 14
  s_add_u32 s32, s32, s58
  s_cmp_eq_u32 s3, 4
  s_cbranch_scc1 L_helper
  s_mov_b32 s6, s32
  s_lshl_b32 s7, s3, 12
  v_add_u32 v1, s7, v1
  v_add_u32 v191, 2097152, v1
  s_getpc_b64 s[20:21]
L_pc:
  s_sub_u32 s20, s20, L_pc-recurrent_scan__gqa_block_cached__dense_activation_relu__decode_kernel
  s_subb_u32 s21, s21, 0
  s_mov_b32 s22, L_codeend-recurrent_scan__gqa_block_cached__dense_activation_relu__decode_kernel
  s_mov_b32 s23, 0x20000
  buffer_load_dwordx4 v[160:163], v1, s[20:23], 0 offen offset:0
  buffer_load_dwordx4 v[164:167], v1, s[20:23], 0 offen offset:1024
  buffer_load_dwordx4 v[168:171], v1, s[20:23], 0 offen offset:2048
  buffer_load_dwordx4 v[172:175], v1, s[20:23], 0 offen offset:3072
  s_lshl_b32 s58, s3, 10
  s_sub_u32 s58, s58, s7
  s_add_u32 s58, s58, 0x4000
  buffer_load_dwordx4 v[160:163], v1, s[20:23], s58 offen
  s_mov_b32 s10, 0x10000000
  s_mov_b32 s11, 0x20000
  s_mov_b32 s14, 0x10000000
  s_mov_b32 s15, 0x20000
  s_waitcnt lgkmcnt(0)
  s_mov_b32 s8, s38
  s_mov_b32 s9, s39
  s_mov_b32 s12, s40
  s_mov_b32 s13, s41
  buffer_load_dwordx4 v[32:35], v1, s[8:11], s6 offen offset:0 nt
  buffer_load_dwordx4 v[36:39], v1, s[8:11], s6 offen offset:1024 nt
  buffer_load_dwordx4 v[40:43], v1, s[8:11], s6 offen offset:2048 nt
  buffer_load_dwordx4 v[44:47], v1, s[8:11], s6 offen offset:3072 nt
  buffer_load_dwordx4 v[48:51], v191, s[8:11], s6 offen offset:0 nt
  buffer_load_dwordx4 v[52:55], v191, s[8:11], s6 offen offset:1024 nt
  s_load_dword s17, s[56:57], 36608
  v_mov_b32 v8, 0
  v_mov_b32 v9, 0
  v_mov_b32 v10, 0
  v_mov_b32 v11, 0
  v_mov_b32 v12, 0
  v_mov_b32 v13, 0
  v_mov_b32 v14, 0
  v_mov_b32 v15, 0
  v_mov_b32 v16, 0xff7fffff
  v_mov_b32 v17, 0
  v_and_b32 v3, 15, v2
  v_lshlrev_b32 v3, 4, v3
  s_lshl_b32 s58, s3, 2
  s_add_u32 s59, s58, 256
  v_mov_b32 v177, s59
  v_lshlrev_b32 v188, 2, v2
  v_lshrrev_b32 v30, 4, v2
  v_add_u32 v30, s58, v30
  v_lshlrev_b32 v181, 2, v30
  v_lshlrev_b32 v30, 9, v30
  v_lshl_add_u32 v180, v3, 1, v30
  v_lshrrev_b32 v30, 5, v2
  v_lshlrev_b32 v183, 5, v30
  v_lshlrev_b32 v30, 12, v30
  v_and_b32 v31, 31, v2
  v_lshl_add_u32 v30, v31, 2, v30
  s_lshl_b32 s58, s3, 7
  v_add_u32 v182, s58, v30
  s_lshl_b32 s59, s3, 8
  s_add_u32 s58, s34, s59
  s_add_u32 s58, s58, 4096
  s_lshl_b32 s60, s5, 10
  s_add_u32 s60, s60, s58
  v_add_u32 v184, s60, v188
  v_and_b32 v30, 7, v2
  v_lshrrev_b32 v31, 3, v2
  v_lshlrev_b32 v18, 10, v30
  v_lshl_add_u32 v18, v31, 4, v18
  v_add_u32 v185, s58, v18
  s_lshl_b32 s58, s4, 17
  s_lshl_b32 s60, s3, 15
  s_add_u32 s58, s58, s60
  s_lshl_b32 s60, s5, 7
  s_add_u32 s58, s58, s60
  v_lshlrev_b32 v18, 12, v31
  v_lshl_add_u32 v18, v30, 4, v18
  v_add_u32 v179, s58, v18
  v_lshlrev_b32 v18, 5, v30
  v_and_b32 v19, 8, v2
  v_lshl_add_u32 v18, v19, 1, v18
  v_bfe_u32 v19, v2, 4, 1
  v_lshl_add_u32 v18, v19, 3, v18
  v_lshrrev_b32 v19, 5, v2
  v_lshl_add_u32 v18, v19, 2, v18
  v_add_u32 v186, s59, v18
  s_lshl_b32 s58, s5, 8
  s_add_u32 s58, s58, s34
  s_add_u32 s58, s58, 14336
  v_add_u32 v187, s58, v188
  s_lshl_b32 s58, s3, 13
  s_add_u32 s58, s58, 16384
  v_add_u32 v192, s58, v188
  s_mov_b32 s28, 0xcccccccc
  s_mov_b32 s29, 0xcccccccc
  s_mov_b32 s24, 0
  s_mov_b32 s25, 0x55555555
  s_mov_b32 s26, 0xff00ff00
  s_mov_b32 s27, 0xff00ff00
  s_waitcnt vmcnt(5)
  buffer_load_dwordx4 v[56:59], v191, s[8:11], s6 offen offset:2048 nt
  s_waitcnt vmcnt(5)
  buffer_load_dwordx4 v[60:63], v191, s[8:11], s6 offen offset:3072 nt
  s_or_b32 s6, s6, 4288806911
  s_add_u32 s6, s6, 1
  s_and_b32 s6, s6, 6160384
  s_or_b32 s6, s6, s32
  s_waitcnt vmcnt(5)
  buffer_load_dwordx4 v[64:67], v1, s[8:11], s6 offen offset:0 nt
  s_waitcnt vmcnt(5)
  buffer_load_dwordx4 v[68:71], v1, s[8:11], s6 offen offset:1024 nt
  s_waitcnt vmcnt(5)
  buffer_load_dwordx4 v[72:75], v1, s[8:11], s6 offen offset:2048 nt
  s_waitcnt vmcnt(5)
  buffer_load_dwordx4 v[76:79], v1, s[8:11], s6 offen offset:3072 nt
  s_waitcnt vmcnt(5)
  buffer_load_dwordx4 v[80:83], v191, s[8:11], s6 offen offset:0 nt
  s_waitcnt vmcnt(5)
  buffer_load_dwordx4 v[84:87], v191, s[8:11], s6 offen offset:1024 nt
  s_waitcnt vmcnt(5)
  buffer_load_dwordx4 v[88:91], v191, s[8:11], s6 offen offset:2048 nt
  s_waitcnt vmcnt(5)
  buffer_load_dwordx4 v[92:95], v191, s[8:11], s6 offen offset:3072 nt
  s_or_b32 s6, s6, 4288806911
  s_add_u32 s6, s6, 1
  s_and_b32 s6, s6, 6160384
  s_or_b32 s6, s6, s32
  s_waitcnt vmcnt(5)
  buffer_load_dwordx4 v[96:99], v1, s[8:11], s6 offen offset:0 nt
  s_waitcnt vmcnt(5)
  buffer_load_dwordx4 v[100:103], v1, s[8:11], s6 offen offset:1024 nt
  s_waitcnt vmcnt(5)
  buffer_load_dwordx4 v[104:107], v1, s[8:11], s6 offen offset:2048 nt
  s_waitcnt vmcnt(5)
  buffer_load_dwordx4 v[108:111], v1, s[8:11], s6 offen offset:3072 nt
  s_waitcnt vmcnt(5)
  buffer_load_dwordx4 v[112:115], v191, s[8:11], s6 offen offset:0 nt
  s_waitcnt vmcnt(5)
  buffer_load_dwordx4 v[116:119], v191, s[8:11], s6 offen offset:1024 nt
  s_waitcnt vmcnt(5)
  buffer_load_dwordx4 v[120:123], v191, s[8:11], s6 offen offset:2048 nt
  s_waitcnt vmcnt(5)
  buffer_load_dwordx4 v[124:127], v191, s[8:11], s6 offen offset:3072 nt
  s_or_b32 s6, s6, 4288806911
  s_add_u32 s6, s6, 1
  s_and_b32 s6, s6, 6160384
  s_or_b32 s6, s6, s32
  s_waitcnt vmcnt(5)
  buffer_load_dwordx4 v[128:131], v1, s[8:11], s6 offen offset:0 nt
  s_waitcnt vmcnt(5)
  buffer_load_dwordx4 v[132:135], v1, s[8:11], s6 offen offset:1024 nt
  s_waitcnt vmcnt(5)
  buffer_load_dwordx4 v[136:139], v1, s[8:11], s6 offen offset:2048 nt
  s_waitcnt vmcnt(5)
  buffer_load_dwordx4 v[140:143], v1, s[8:11], s6 offen offset:3072 nt
  s_waitcnt vmcnt(5)
  buffer_load_dwordx4 v[144:147], v191, s[8:11], s6 offen offset:0 nt
  s_waitcnt vmcnt(5)
  buffer_load_dwordx4 v[148:151], v191, s[8:11], s6 offen offset:1024 nt
  s_waitcnt vmcnt(5)
  buffer_load_dwordx4 v[152:155], v191, s[8:11], s6 offen offset:2048 nt
  s_waitcnt vmcnt(5)
  buffer_load_dwordx4 v[156:159], v191, s[8:11], s6 offen offset:3072 nt
  s_or_b32 s6, s6, 4288806911
  s_add_u32 s6, s6, 1
  s_and_b32 s6, s6, 6160384
  s_or_b32 s6, s6, s32
  s_barrier
  ds_read_b128 v[4:7], v3 offset:0
  s_waitcnt lgkmcnt(0)
  s_add_u32 s17, s17, 1
  s_and_b32 s17, s17, 63
  s_waitcnt vmcnt(31)
  v_dot2_f32_bf16 v18, v32, v4, 0
  v_dot2_f32_bf16 v18, v33, v5, v18
  v_dot2_f32_bf16 v18, v34, v6, v18
  v_dot2_f32_bf16 v18, v35, v7, v18
  buffer_load_dwordx4 v[32:35], v1, s[8:11], s6 offen offset:0 nt
  s_waitcnt vmcnt(31)
  v_dot2_f32_bf16 v19, v36, v4, 0
  v_dot2_f32_bf16 v19, v37, v5, v19
  v_dot2_f32_bf16 v19, v38, v6, v19
  v_dot2_f32_bf16 v19, v39, v7, v19
  buffer_load_dwordx4 v[36:39], v1, s[8:11], s6 offen offset:1024 nt
  s_waitcnt vmcnt(31)
  v_dot2_f32_bf16 v20, v40, v4, 0
  v_dot2_f32_bf16 v20, v41, v5, v20
  v_dot2_f32_bf16 v20, v42, v6, v20
  v_dot2_f32_bf16 v20, v43, v7, v20
  buffer_load_dwordx4 v[40:43], v1, s[8:11], s6 offen offset:2048 nt
  s_waitcnt vmcnt(31)
  v_dot2_f32_bf16 v21, v44, v4, 0
  v_dot2_f32_bf16 v21, v45, v5, v21
  v_dot2_f32_bf16 v21, v46, v6, v21
  v_dot2_f32_bf16 v21, v47, v7, v21
  buffer_load_dwordx4 v[44:47], v1, s[8:11], s6 offen offset:3072 nt
  s_waitcnt vmcnt(31)
  v_dot2_f32_bf16 v22, v48, v4, 0
  v_dot2_f32_bf16 v22, v49, v5, v22
  v_dot2_f32_bf16 v22, v50, v6, v22
  v_dot2_f32_bf16 v22, v51, v7, v22
  buffer_load_dwordx4 v[48:51], v191, s[8:11], s6 offen offset:0 nt
  s_waitcnt vmcnt(31)
  v_dot2_f32_bf16 v23, v52, v4, 0
  v_dot2_f32_bf16 v23, v53, v5, v23
  v_dot2_f32_bf16 v23, v54, v6, v23
  v_dot2_f32_bf16 v23, v55, v7, v23
  buffer_load_dwordx4 v[52:55], v191, s[8:11], s6 offen offset:1024 nt
  s_waitcnt vmcnt(31)
  v_dot2_f32_bf16 v24, v56, v4, 0
  v_dot2_f32_bf16 v24, v57, v5, v24
  v_dot2_f32_bf16 v24, v58, v6, v24
  v_dot2_f32_bf16 v24, v59, v7, v24
  buffer_load_dwordx4 v[56:59], v191, s[8:11], s6 offen offset:2048 nt
  s_waitcnt vmcnt(31)
  v_dot2_f32_bf16 v25, v60, v4, 0
  v_dot2_f32_bf16 v25, v61, v5, v25
  v_dot2_f32_bf16 v25, v62, v6, v25
  v_dot2_f32_bf16 v25, v63, v7, v25
  v_add_f32_dpp v18, v18, v18 row_ror:8 row_mask:0xf bank_mask:0x3
  v_add_f32_dpp v20, v20, v20 row_ror:8 row_mask:0xf bank_mask:0x3
  v_add_f32_dpp v22, v22, v22 row_ror:8 row_mask:0xf bank_mask:0x3
  v_add_f32_dpp v24, v24, v24 row_ror:8 row_mask:0xf bank_mask:0x3
  v_add_f32_dpp v18, v19, v19 row_ror:8 row_mask:0xf bank_mask:0xc
  v_add_f32_dpp v20, v21, v21 row_ror:8 row_mask:0xf bank_mask:0xc
  v_add_f32_dpp v22, v23, v23 row_ror:8 row_mask:0xf bank_mask:0xc
  v_add_f32_dpp v24, v25, v25 row_ror:8 row_mask:0xf bank_mask:0xc
  v_add_f32_dpp v18, v18, v18 row_shl:4 row_mask:0xf bank_mask:0x5
  s_nop 0
  v_add_f32_dpp v22, v22, v22 row_shl:4 row_mask:0xf bank_mask:0x5
  v_add_f32_dpp v18, v20, v20 row_shr:4 row_mask:0xf bank_mask:0xa
  v_add_f32_dpp v22, v24, v24 row_shr:4 row_mask:0xf bank_mask:0xa
  s_nop 0
  v_add_f32_dpp v18, v18, v18 quad_perm:[2,3,0,1] row_mask:0xf bank_mask:0xf
  v_add_f32_dpp v22, v22, v22 quad_perm:[2,3,0,1] row_mask:0xf bank_mask:0xf
  v_cndmask_b32 v18, v18, v22, s[28:29]
  s_nop 1
  v_add_f32_dpp v18, v18, v18 quad_perm:[1,0,3,2] row_mask:0xf bank_mask:0xf
  ds_write_b32 v192, v18
  v_max_f32 v16, v16, v18
  v_add_u32 v192, 0x100, v192
  buffer_load_dwordx4 v[60:63], v191, s[8:11], s6 offen offset:3072 nt
  s_or_b32 s6, s6, 4288806911
  s_add_u32 s6, s6, 1
  s_and_b32 s6, s6, 6160384
  s_or_b32 s6, s6, s32
  s_waitcnt vmcnt(31)
  v_dot2_f32_bf16 v18, v64, v4, 0
  v_dot2_f32_bf16 v18, v65, v5, v18
  v_dot2_f32_bf16 v18, v66, v6, v18
  v_dot2_f32_bf16 v18, v67, v7, v18
  buffer_load_dwordx4 v[64:67], v1, s[8:11], s6 offen offset:0 nt
  s_waitcnt vmcnt(31)
  v_dot2_f32_bf16 v19, v68, v4, 0
  v_dot2_f32_bf16 v19, v69, v5, v19
  v_dot2_f32_bf16 v19, v70, v6, v19
  v_dot2_f32_bf16 v19, v71, v7, v19
  buffer_load_dwordx4 v[68:71], v1, s[8:11], s6 offen offset:1024 nt
  s_waitcnt vmcnt(31)
  v_dot2_f32_bf16 v20, v72, v4, 0
  v_dot2_f32_bf16 v20, v73, v5, v20
  v_dot2_f32_bf16 v20, v74, v6, v20
  v_dot2_f32_bf16 v20, v75, v7, v20
  buffer_load_dwordx4 v[72:75], v1, s[8:11], s6 offen offset:2048 nt
  s_waitcnt vmcnt(31)
  v_dot2_f32_bf16 v21, v76, v4, 0
  v_dot2_f32_bf16 v21, v77, v5, v21
  v_dot2_f32_bf16 v21, v78, v6, v21
  v_dot2_f32_bf16 v21, v79, v7, v21
  buffer_load_dwordx4 v[76:79], v1, s[8:11], s6 offen offset:3072 nt
  s_waitcnt vmcnt(31)
  v_dot2_f32_bf16 v22, v80, v4, 0
  v_dot2_f32_bf16 v22, v81, v5, v22
  v_dot2_f32_bf16 v22, v82, v6, v22
  v_dot2_f32_bf16 v22, v83, v7, v22
  s_waitcnt vmcnt(30)
  v_dot2_f32_bf16 v23, v84, v4, 0
  v_dot2_f32_bf16 v23, v85, v5, v23
  v_dot2_f32_bf16 v23, v86, v6, v23
  v_dot2_f32_bf16 v23, v87, v7, v23
  s_waitcnt vmcnt(29)
  v_dot2_f32_bf16 v24, v88, v4, 0
  v_dot2_f32_bf16 v24, v89, v5, v24
  v_dot2_f32_bf16 v24, v90, v6, v24
  v_dot2_f32_bf16 v24, v91, v7, v24
  s_waitcnt vmcnt(28)
  v_dot2_f32_bf16 v25, v92, v4, 0
  v_dot2_f32_bf16 v25, v93, v5, v25
  v_dot2_f32_bf16 v25, v94, v6, v25
  v_dot2_f32_bf16 v25, v95, v7, v25
  v_add_f32_dpp v18, v18, v18 row_ror:8 row_mask:0xf bank_mask:0x3
  v_add_f32_dpp v20, v20, v20 row_ror:8 row_mask:0xf bank_mask:0x3
  v_add_f32_dpp v22, v22, v22 row_ror:8 row_mask:0xf bank_mask:0x3
  v_add_f32_dpp v24, v24, v24 row_ror:8 row_mask:0xf bank_mask:0x3
  v_add_f32_dpp v18, v19, v19 row_ror:8 row_mask:0xf bank_mask:0xc
  v_add_f32_dpp v20, v21, v21 row_ror:8 row_mask:0xf bank_mask:0xc
  v_add_f32_dpp v22, v23, v23 row_ror:8 row_mask:0xf bank_mask:0xc
  v_add_f32_dpp v24, v25, v25 row_ror:8 row_mask:0xf bank_mask:0xc
  v_add_f32_dpp v18, v18, v18 row_shl:4 row_mask:0xf bank_mask:0x5
  s_nop 0
  v_add_f32_dpp v22, v22, v22 row_shl:4 row_mask:0xf bank_mask:0x5
  v_add_f32_dpp v18, v20, v20 row_shr:4 row_mask:0xf bank_mask:0xa
  v_add_f32_dpp v22, v24, v24 row_shr:4 row_mask:0xf bank_mask:0xa
  s_nop 0
  v_add_f32_dpp v18, v18, v18 quad_perm:[2,3,0,1] row_mask:0xf bank_mask:0xf
  v_add_f32_dpp v22, v22, v22 quad_perm:[2,3,0,1] row_mask:0xf bank_mask:0xf
  v_cndmask_b32 v18, v18, v22, s[28:29]
  s_nop 1
  v_add_f32_dpp v18, v18, v18 quad_perm:[1,0,3,2] row_mask:0xf bank_mask:0xf
  ds_write_b32 v192, v18
  v_max_f32 v16, v16, v18
  v_add_u32 v192, 0x100, v192
  s_waitcnt vmcnt(27)
  v_dot2_f32_bf16 v18, v96, v4, 0
  v_dot2_f32_bf16 v18, v97, v5, v18
  v_dot2_f32_bf16 v18, v98, v6, v18
  v_dot2_f32_bf16 v18, v99, v7, v18
  s_waitcnt vmcnt(26)
  v_dot2_f32_bf16 v19, v100, v4, 0
  v_dot2_f32_bf16 v19, v101, v5, v19
  v_dot2_f32_bf16 v19, v102, v6, v19
  v_dot2_f32_bf16 v19, v103, v7, v19
  s_waitcnt vmcnt(25)
  v_dot2_f32_bf16 v20, v104, v4, 0
  v_dot2_f32_bf16 v20, v105, v5, v20
  v_dot2_f32_bf16 v20, v106, v6, v20
  v_dot2_f32_bf16 v20, v107, v7, v20
  s_waitcnt vmcnt(24)
  v_dot2_f32_bf16 v21, v108, v4, 0
  v_dot2_f32_bf16 v21, v109, v5, v21
  v_dot2_f32_bf16 v21, v110, v6, v21
  v_dot2_f32_bf16 v21, v111, v7, v21
  s_waitcnt vmcnt(23)
  v_dot2_f32_bf16 v22, v112, v4, 0
  v_dot2_f32_bf16 v22, v113, v5, v22
  v_dot2_f32_bf16 v22, v114, v6, v22
  v_dot2_f32_bf16 v22, v115, v7, v22
  s_waitcnt vmcnt(22)
  v_dot2_f32_bf16 v23, v116, v4, 0
  v_dot2_f32_bf16 v23, v117, v5, v23
  v_dot2_f32_bf16 v23, v118, v6, v23
  v_dot2_f32_bf16 v23, v119, v7, v23
  s_waitcnt vmcnt(21)
  v_dot2_f32_bf16 v24, v120, v4, 0
  v_dot2_f32_bf16 v24, v121, v5, v24
  v_dot2_f32_bf16 v24, v122, v6, v24
  v_dot2_f32_bf16 v24, v123, v7, v24
  s_waitcnt vmcnt(20)
  v_dot2_f32_bf16 v25, v124, v4, 0
  v_dot2_f32_bf16 v25, v125, v5, v25
  v_dot2_f32_bf16 v25, v126, v6, v25
  v_dot2_f32_bf16 v25, v127, v7, v25
  v_add_f32_dpp v18, v18, v18 row_ror:8 row_mask:0xf bank_mask:0x3
  v_add_f32_dpp v20, v20, v20 row_ror:8 row_mask:0xf bank_mask:0x3
  v_add_f32_dpp v22, v22, v22 row_ror:8 row_mask:0xf bank_mask:0x3
  v_add_f32_dpp v24, v24, v24 row_ror:8 row_mask:0xf bank_mask:0x3
  v_add_f32_dpp v18, v19, v19 row_ror:8 row_mask:0xf bank_mask:0xc
  v_add_f32_dpp v20, v21, v21 row_ror:8 row_mask:0xf bank_mask:0xc
  v_add_f32_dpp v22, v23, v23 row_ror:8 row_mask:0xf bank_mask:0xc
  v_add_f32_dpp v24, v25, v25 row_ror:8 row_mask:0xf bank_mask:0xc
  v_add_f32_dpp v18, v18, v18 row_shl:4 row_mask:0xf bank_mask:0x5
  s_nop 0
  v_add_f32_dpp v22, v22, v22 row_shl:4 row_mask:0xf bank_mask:0x5
  v_add_f32_dpp v18, v20, v20 row_shr:4 row_mask:0xf bank_mask:0xa
  v_add_f32_dpp v22, v24, v24 row_shr:4 row_mask:0xf bank_mask:0xa
  s_nop 0
  v_add_f32_dpp v18, v18, v18 quad_perm:[2,3,0,1] row_mask:0xf bank_mask:0xf
  v_add_f32_dpp v22, v22, v22 quad_perm:[2,3,0,1] row_mask:0xf bank_mask:0xf
  v_cndmask_b32 v18, v18, v22, s[28:29]
  s_nop 1
  v_add_f32_dpp v18, v18, v18 quad_perm:[1,0,3,2] row_mask:0xf bank_mask:0xf
  ds_write_b32 v192, v18
  v_max_f32 v16, v16, v18
  v_add_u32 v192, 0x100, v192
  s_waitcnt vmcnt(19)
  v_dot2_f32_bf16 v18, v128, v4, 0
  v_dot2_f32_bf16 v18, v129, v5, v18
  v_dot2_f32_bf16 v18, v130, v6, v18
  v_dot2_f32_bf16 v18, v131, v7, v18
  s_waitcnt vmcnt(18)
  v_dot2_f32_bf16 v19, v132, v4, 0
  v_dot2_f32_bf16 v19, v133, v5, v19
  v_dot2_f32_bf16 v19, v134, v6, v19
  v_dot2_f32_bf16 v19, v135, v7, v19
  s_waitcnt vmcnt(17)
  v_dot2_f32_bf16 v20, v136, v4, 0
  v_dot2_f32_bf16 v20, v137, v5, v20
  v_dot2_f32_bf16 v20, v138, v6, v20
  v_dot2_f32_bf16 v20, v139, v7, v20
  s_waitcnt vmcnt(16)
  v_dot2_f32_bf16 v21, v140, v4, 0
  v_dot2_f32_bf16 v21, v141, v5, v21
  v_dot2_f32_bf16 v21, v142, v6, v21
  v_dot2_f32_bf16 v21, v143, v7, v21
  s_waitcnt vmcnt(15)
  v_dot2_f32_bf16 v22, v144, v4, 0
  v_dot2_f32_bf16 v22, v145, v5, v22
  v_dot2_f32_bf16 v22, v146, v6, v22
  v_dot2_f32_bf16 v22, v147, v7, v22
  s_waitcnt vmcnt(14)
  v_dot2_f32_bf16 v23, v148, v4, 0
  v_dot2_f32_bf16 v23, v149, v5, v23
  v_dot2_f32_bf16 v23, v150, v6, v23
  v_dot2_f32_bf16 v23, v151, v7, v23
  s_waitcnt vmcnt(13)
  v_dot2_f32_bf16 v24, v152, v4, 0
  v_dot2_f32_bf16 v24, v153, v5, v24
  v_dot2_f32_bf16 v24, v154, v6, v24
  v_dot2_f32_bf16 v24, v155, v7, v24
  s_waitcnt vmcnt(12)
  v_dot2_f32_bf16 v25, v156, v4, 0
  v_dot2_f32_bf16 v25, v157, v5, v25
  v_dot2_f32_bf16 v25, v158, v6, v25
  v_dot2_f32_bf16 v25, v159, v7, v25
  v_add_f32_dpp v18, v18, v18 row_ror:8 row_mask:0xf bank_mask:0x3
  v_add_f32_dpp v20, v20, v20 row_ror:8 row_mask:0xf bank_mask:0x3
  v_add_f32_dpp v22, v22, v22 row_ror:8 row_mask:0xf bank_mask:0x3
  v_add_f32_dpp v24, v24, v24 row_ror:8 row_mask:0xf bank_mask:0x3
  v_add_f32_dpp v18, v19, v19 row_ror:8 row_mask:0xf bank_mask:0xc
  v_add_f32_dpp v20, v21, v21 row_ror:8 row_mask:0xf bank_mask:0xc
  v_add_f32_dpp v22, v23, v23 row_ror:8 row_mask:0xf bank_mask:0xc
  v_add_f32_dpp v24, v25, v25 row_ror:8 row_mask:0xf bank_mask:0xc
  v_add_f32_dpp v18, v18, v18 row_shl:4 row_mask:0xf bank_mask:0x5
  s_nop 0
  v_add_f32_dpp v22, v22, v22 row_shl:4 row_mask:0xf bank_mask:0x5
  v_add_f32_dpp v18, v20, v20 row_shr:4 row_mask:0xf bank_mask:0xa
  v_add_f32_dpp v22, v24, v24 row_shr:4 row_mask:0xf bank_mask:0xa
  s_nop 0
  v_add_f32_dpp v18, v18, v18 quad_perm:[2,3,0,1] row_mask:0xf bank_mask:0xf
  v_add_f32_dpp v22, v22, v22 quad_perm:[2,3,0,1] row_mask:0xf bank_mask:0xf
  v_cndmask_b32 v18, v18, v22, s[28:29]
  s_nop 1
  v_add_f32_dpp v18, v18, v18 quad_perm:[1,0,3,2] row_mask:0xf bank_mask:0xf
  ds_write_b32 v192, v18
  v_max_f32 v16, v16, v18
  v_add_u32 v192, 0x100, v192
  s_waitcnt vmcnt(11)
  v_dot2_f32_bf16 v18, v32, v4, 0
  v_dot2_f32_bf16 v18, v33, v5, v18
  v_dot2_f32_bf16 v18, v34, v6, v18
  v_dot2_f32_bf16 v18, v35, v7, v18
  s_waitcnt vmcnt(10)
  v_dot2_f32_bf16 v19, v36, v4, 0
  v_dot2_f32_bf16 v19, v37, v5, v19
  v_dot2_f32_bf16 v19, v38, v6, v19
  v_dot2_f32_bf16 v19, v39, v7, v19
  s_waitcnt vmcnt(9)
  v_dot2_f32_bf16 v20, v40, v4, 0
  v_dot2_f32_bf16 v20, v41, v5, v20
  v_dot2_f32_bf16 v20, v42, v6, v20
  v_dot2_f32_bf16 v20, v43, v7, v20
  s_waitcnt vmcnt(8)
  v_dot2_f32_bf16 v21, v44, v4, 0
  v_dot2_f32_bf16 v21, v45, v5, v21
  v_dot2_f32_bf16 v21, v46, v6, v21
  v_dot2_f32_bf16 v21, v47, v7, v21
  s_waitcnt vmcnt(7)
  v_dot2_f32_bf16 v22, v48, v4, 0
  v_dot2_f32_bf16 v22, v49, v5, v22
  v_dot2_f32_bf16 v22, v50, v6, v22
  v_dot2_f32_bf16 v22, v51, v7, v22
  s_mov_b32 s7, 1048576
  v_mov_b32 v0, 12312
  v_mov_b32 v190, 0
  v_mov_b32 v194, 2952
  s_mov_b64 vcc, 0
  ds_read_b64 v[196:197], v194
  s_mov_b64 s[64:65], 0
  s_mov_b32 s31, 0
  s_mov_b32 s30, 13
  s_branch L_entryk
L_loopk:
  s_cbranch_vccnz L_w1
  s_waitcnt vmcnt(4)
L_w1:
  s_waitcnt vmcnt(6)
  buffer_load_dwordx4 v[60:63], v191, s[8:11], s6 offen offset:3072 nt
  v_dot2_f32_bf16 v18, v32, v4, 0
  v_dot2_f32_bf16 v18, v33, v5, v18
  v_dot2_f32_bf16 v18, v34, v6, v18
  v_dot2_f32_bf16 v18, v35, v7, v18
  ds_write_b32 v177, v0
  v_add_u32 v0, 4, v0
  s_or_b32 s6, s6, 4288806911
  s_add_u32 s6, s6, 1
  s_and_b32 s6, s6, 6160384
  s_or_b32 s6, s6, s32
  s_cbranch_vccnz L_w2
  s_waitcnt vmcnt(4)
L_w2:
  s_waitcnt vmcnt(6)
  buffer_load_dwordx4 v[64:67], v1, s[8:11], s6 offen offset:0 nt
  v_dot2_f32_bf16 v19, v36, v4, 0
  v_dot2_f32_bf16 v19, v37, v5, v19
  v_dot2_f32_bf16 v19, v38, v6, v19
  v_dot2_f32_bf16 v19, v39, v7, v19
  s_cbranch_vccnz L_w3
  s_waitcnt vmcnt(4)
L_w3:
  s_waitcnt vmcnt(6)
  buffer_load_dwordx4 v[68:71], v1, s[8:11], s6 offen offset:1024 nt
  v_dot2_f32_bf16 v20, v40, v4, 0
  v_dot2_f32_bf16 v20, v41, v5, v20
  v_dot2_f32_bf16 v20, v42, v6, v20
  v_dot2_f32_bf16 v20, v43, v7, v20
  ds_read_b64 v[196:197], v194
  s_cbranch_vccnz L_w4
  s_waitcnt vmcnt(4)
L_w4:
  s_waitcnt vmcnt(6)
  buffer_load_dwordx4 v[72:75], v1, s[8:11], s6 offen offset:2048 nt
  v_dot2_f32_bf16 v21, v44, v4, 0
  v_dot2_f32_bf16 v21, v45, v5, v21
  v_dot2_f32_bf16 v21, v46, v6, v21
  v_dot2_f32_bf16 v21, v47, v7, v21
  s_cbranch_vccnz L_w5
  s_waitcnt vmcnt(4)
L_w5:
  s_waitcnt vmcnt(6)
  buffer_load_dwordx4 v[76:79], v1, s[8:11], s6 offen offset:3072 nt
  v_dot2_f32_bf16 v22, v48, v4, 0
  v_dot2_f32_bf16 v22, v49, v5, v22
  v_dot2_f32_bf16 v22, v50, v6, v22
  v_dot2_f32_bf16 v22, v51, v7, v22
L_entryk:
  s_memrealtime s[62:63]
  s_cbranch_vccnz L_w6
  s_waitcnt vmcnt(4)
L_w6:
  s_waitcnt vmcnt(6)
  buffer_load_dwordx4 v[80:83], v191, s[8:11], s6 offen offset:0 nt
  v_dot2_f32_bf16 v23, v52, v4, 0
  v_dot2_f32_bf16 v23, v53, v5, v23
  v_dot2_f32_bf16 v23, v54, v6, v23
  v_dot2_f32_bf16 v23, v55, v7, v23
  s_waitcnt lgkmcnt(0)
  s_lshl_b32 s62, s62, 6
  v_mad_u32_u24 v190, v0, v197, v196
  v_sub_u32 v190, s62, v190
  v_cmp_lt_i32 vcc, 0, v190
  s_cbranch_vccnz L_w7
  s_waitcnt vmcnt(4)
L_w7:
  s_waitcnt vmcnt(6)
  buffer_load_dwordx4 v[84:87], v191, s[8:11], s6 offen offset:1024 nt
  v_dot2_f32_bf16 v24, v56, v4, 0
  v_dot2_f32_bf16 v24, v57, v5, v24
  v_dot2_f32_bf16 v24, v58, v6, v24
  v_dot2_f32_bf16 v24, v59, v7, v24
  s_cbranch_vccnz L_w8
  s_waitcnt vmcnt(4)
L_w8:
  s_waitcnt vmcnt(6)
  buffer_load_dwordx4 v[88:91], v191, s[8:11], s6 offen offset:2048 nt
  v_dot2_f32_bf16 v25, v60, v4, 0
  v_dot2_f32_bf16 v25, v61, v5, v25
  v_dot2_f32_bf16 v25, v62, v6, v25
  v_dot2_f32_bf16 v25, v63, v7, v25
  v_add_f32_dpp v18, v18, v18 row_ror:8 row_mask:0xf bank_mask:0x3
  v_add_f32_dpp v20, v20, v20 row_ror:8 row_mask:0xf bank_mask:0x3
  v_add_f32_dpp v22, v22, v22 row_ror:8 row_mask:0xf bank_mask:0x3
  v_add_f32_dpp v24, v24, v24 row_ror:8 row_mask:0xf bank_mask:0x3
  v_add_f32_dpp v18, v19, v19 row_ror:8 row_mask:0xf bank_mask:0xc
  v_add_f32_dpp v20, v21, v21 row_ror:8 row_mask:0xf bank_mask:0xc
  v_add_f32_dpp v22, v23, v23 row_ror:8 row_mask:0xf bank_mask:0xc
  v_add_f32_dpp v24, v25, v25 row_ror:8 row_mask:0xf bank_mask:0xc
  v_add_f32_dpp v18, v18, v18 row_shl:4 row_mask:0xf bank_mask:0x5
  s_nop 0
  v_add_f32_dpp v22, v22, v22 row_shl:4 row_mask:0xf bank_mask:0x5
  v_add_f32_dpp v18, v20, v20 row_shr:4 row_mask:0xf bank_mask:0xa
  v_add_f32_dpp v22, v24, v24 row_shr:4 row_mask:0xf bank_mask:0xa
  s_nop 0
  v_add_f32_dpp v18, v18, v18 quad_perm:[2,3,0,1] row_mask:0xf bank_mask:0xf
  v_add_f32_dpp v22, v22, v22 quad_perm:[2,3,0,1] row_mask:0xf bank_mask:0xf
  v_cndmask_b32 v18, v18, v22, s[28:29]
  s_nop 1
  v_add_f32_dpp v18, v18, v18 quad_perm:[1,0,3,2] row_mask:0xf bank_mask:0xf
  ds_write_b32 v192, v18
  v_max_f32 v16, v16, v18
  v_add_u32 v192, 0x100, v192
  s_sub_u32 s30, s30, 1
  s_cbranch_scc1 L_lastk
  s_cbranch_vccnz L_w9
  s_waitcnt vmcnt(4)
L_w9:
  s_waitcnt vmcnt(6)
  buffer_load_dwordx4 v[92:95], v191, s[8:11], s6 offen offset:3072 nt
  v_dot2_f32_bf16 v18, v64, v4, 0
  v_dot2_f32_bf16 v18, v65, v5, v18
  v_dot2_f32_bf16 v18, v66, v6, v18
  v_dot2_f32_bf16 v18, v67, v7, v18
  ds_write_b32 v177, v0
  v_add_u32 v0, 4, v0
  s_or_b32 s6, s6, 4288806911
  s_add_u32 s6, s6, 1
  s_and_b32 s6, s6, 6160384
  s_or_b32 s6, s6, s32
  s_cbranch_vccnz L_w10
  s_waitcnt vmcnt(4)
L_w10:
  s_waitcnt vmcnt(6)
  buffer_load_dwordx4 v[32:35], v1, s[8:11], s6 offen offset:0 nt
  v_dot2_f32_bf16 v19, v68, v4, 0
  v_dot2_f32_bf16 v19, v69, v5, v19
  v_dot2_f32_bf16 v19, v70, v6, v19
  v_dot2_f32_bf16 v19, v71, v7, v19
  s_cbranch_vccnz L_w11
  s_waitcnt vmcnt(4)
L_w11:
  s_waitcnt vmcnt(6)
  buffer_load_dwordx4 v[36:39], v1, s[8:11], s6 offen offset:1024 nt
  v_dot2_f32_bf16 v20, v72, v4, 0
  v_dot2_f32_bf16 v20, v73, v5, v20
  v_dot2_f32_bf16 v20, v74, v6, v20
  v_dot2_f32_bf16 v20, v75, v7, v20
  ds_read_b64 v[196:197], v194
  s_cbranch_vccnz L_w12
  s_waitcnt vmcnt(4)
L_w12:
  s_waitcnt vmcnt(6)
  buffer_load_dwordx4 v[40:43], v1, s[8:11], s6 offen offset:2048 nt
  v_dot2_f32_bf16 v21, v76, v4, 0
  v_dot2_f32_bf16 v21, v77, v5, v21
  v_dot2_f32_bf16 v21, v78, v6, v21
  v_dot2_f32_bf16 v21, v79, v7, v21
  s_cbranch_vccnz L_w13
  s_waitcnt vmcnt(4)
L_w13:
  s_waitcnt vmcnt(6)
  buffer_load_dwordx4 v[44:47], v1, s[8:11], s6 offen offset:3072 nt
  v_dot2_f32_bf16 v22, v80, v4, 0
  v_dot2_f32_bf16 v22, v81, v5, v22
  v_dot2_f32_bf16 v22, v82, v6, v22
  v_dot2_f32_bf16 v22, v83, v7, v22
  s_memrealtime s[62:63]
  s_cbranch_vccnz L_w14
  s_waitcnt vmcnt(4)
L_w14:
  s_waitcnt vmcnt(6)
  buffer_load_dwordx4 v[48:51], v191, s[8:11], s6 offen offset:0 nt
  v_dot2_f32_bf16 v23, v84, v4, 0
  v_dot2_f32_bf16 v23, v85, v5, v23
  v_dot2_f32_bf16 v23, v86, v6, v23
  v_dot2_f32_bf16 v23, v87, v7, v23
  s_waitcnt lgkmcnt(0)
  s_lshl_b32 s62, s62, 6
  v_mad_u32_u24 v190, v0, v197, v196
  v_sub_u32 v190, s62, v190
  v_cmp_lt_i32 vcc, 0, v190
  s_cbranch_vccnz L_w15
  s_waitcnt vmcnt(4)
L_w15:
  s_waitcnt vmcnt(6)
  buffer_load_dwordx4 v[52:55], v191, s[8:11], s6 offen offset:1024 nt
  v_dot2_f32_bf16 v24, v88, v4, 0
  v_dot2_f32_bf16 v24, v89, v5, v24
  v_dot2_f32_bf16 v24, v90, v6, v24
  v_dot2_f32_bf16 v24, v91, v7, v24
  s_cbranch_vccnz L_w16
  s_waitcnt vmcnt(4)
L_w16:
  s_waitcnt vmcnt(6)
  buffer_load_dwordx4 v[56:59], v191, s[8:11], s6 offen offset:2048 nt
  v_dot2_f32_bf16 v25, v92, v4, 0
  v_dot2_f32_bf16 v25, v93, v5, v25
  v_dot2_f32_bf16 v25, v94, v6, v25
  v_dot2_f32_bf16 v25, v95, v7, v25
  v_add_f32_dpp v18, v18, v18 row_ror:8 row_mask:0xf bank_mask:0x3
  v_add_f32_dpp v20, v20, v20 row_ror:8 row_mask:0xf bank_mask:0x3
  v_add_f32_dpp v22, v22, v22 row_ror:8 row_mask:0xf bank_mask:0x3
  v_add_f32_dpp v24, v24, v24 row_ror:8 row_mask:0xf bank_mask:0x3
  v_add_f32_dpp v18, v19, v19 row_ror:8 row_mask:0xf bank_mask:0xc
  v_add_f32_dpp v20, v21, v21 row_ror:8 row_mask:0xf bank_mask:0xc
  v_add_f32_dpp v22, v23, v23 row_ror:8 row_mask:0xf bank_mask:0xc
  v_add_f32_dpp v24, v25, v25 row_ror:8 row_mask:0xf bank_mask:0xc
  v_add_f32_dpp v18, v18, v18 row_shl:4 row_mask:0xf bank_mask:0x5
  s_nop 0
  v_add_f32_dpp v22, v22, v22 row_shl:4 row_mask:0xf bank_mask:0x5
  v_add_f32_dpp v18, v20, v20 row_shr:4 row_mask:0xf bank_mask:0xa
  v_add_f32_dpp v22, v24, v24 row_shr:4 row_mask:0xf bank_mask:0xa
  s_nop 0
  v_add_f32_dpp v18, v18, v18 quad_perm:[2,3,0,1] row_mask:0xf bank_mask:0xf
  v_add_f32_dpp v22, v22, v22 quad_perm:[2,3,0,1] row_mask:0xf bank_mask:0xf
  v_cndmask_b32 v18, v18, v22, s[28:29]
  s_nop 1
  v_add_f32_dpp v18, v18, v18 quad_perm:[1,0,3,2] row_mask:0xf bank_mask:0xf
  ds_write_b32 v192, v18
  v_max_f32 v16, v16, v18
  v_add_u32 v192, 0x100, v192
  s_branch L_loopk
L_lastk:
  s_cbranch_vccnz L_w17
  s_waitcnt vmcnt(4)
L_w17:
  s_waitcnt vmcnt(6)
  buffer_load_dwordx4 v[92:95], v191, s[8:11], s6 offen offset:3072 nt
  v_dot2_f32_bf16 v18, v64, v4, 0
  v_dot2_f32_bf16 v18, v65, v5, v18
  v_dot2_f32_bf16 v18, v66, v6, v18
  v_dot2_f32_bf16 v18, v67, v7, v18
  ds_write_b32 v177, v0
  v_add_u32 v0, 4, v0
  s_mov_b32 s6, s32
  s_cbranch_vccnz L_w18
  s_waitcnt vmcnt(4)
L_w18:
  s_waitcnt vmcnt(6)
  buffer_load_dwordx4 v[32:35], v1, s[12:15], s6 offen offset:0 nt
  v_dot2_f32_bf16 v19, v68, v4, 0
  v_dot2_f32_bf16 v19, v69, v5, v19
  v_dot2_f32_bf16 v19, v70, v6, v19
  v_dot2_f32_bf16 v19, v71, v7, v19
  s_cbranch_vccnz L_w19
  s_waitcnt vmcnt(4)
L_w19:
  s_waitcnt vmcnt(6)
  buffer_load_dwordx4 v[36:39], v1, s[12:15], s6 offen offset:1024 nt
  v_dot2_f32_bf16 v20, v72, v4, 0
  v_dot2_f32_bf16 v20, v73, v5, v20
  v_dot2_f32_bf16 v20, v74, v6, v20
  v_dot2_f32_bf16 v20, v75, v7, v20
  ds_read_b64 v[196:197], v194
  s_cbranch_vccnz L_w20
  s_waitcnt vmcnt(4)
L_w20:
  s_waitcnt vmcnt(6)
  buffer_load_dwordx4 v[40:43], v1, s[12:15], s6 offen offset:2048 nt
  v_dot2_f32_bf16 v21, v76, v4, 0
  v_dot2_f32_bf16 v21, v77, v5, v21
  v_dot2_f32_bf16 v21, v78, v6, v21
  v_dot2_f32_bf16 v21, v79, v7, v21
  s_cbranch_vccnz L_w21
  s_waitcnt vmcnt(4)
L_w21:
  s_waitcnt vmcnt(6)
  buffer_load_dwordx4 v[44:47], v1, s[12:15], s6 offen offset:3072 nt
  v_dot2_f32_bf16 v22, v80, v4, 0
  v_dot2_f32_bf16 v22, v81, v5, v22
  v_dot2_f32_bf16 v22, v82, v6, v22
  v_dot2_f32_bf16 v22, v83, v7, v22
  s_memrealtime s[62:63]
  s_cbranch_vccnz L_w22
  s_waitcnt vmcnt(4)
L_w22:
  s_waitcnt vmcnt(6)
  buffer_load_dwordx4 v[48:51], v191, s[12:15], s6 offen offset:0 nt
  v_dot2_f32_bf16 v23, v84, v4, 0
  v_dot2_f32_bf16 v23, v85, v5, v23
  v_dot2_f32_bf16 v23, v86, v6, v23
  v_dot2_f32_bf16 v23, v87, v7, v23
  s_waitcnt lgkmcnt(0)
  s_lshl_b32 s62, s62, 6
  v_mad_u32_u24 v190, v0, v197, v196
  v_sub_u32 v190, s62, v190
  v_cmp_lt_i32 vcc, 0, v190
  s_cbranch_vccnz L_w23
  s_waitcnt vmcnt(4)
L_w23:
  s_waitcnt vmcnt(6)
  buffer_load_dwordx4 v[52:55], v191, s[12:15], s6 offen offset:1024 nt
  v_dot2_f32_bf16 v24, v88, v4, 0
  v_dot2_f32_bf16 v24, v89, v5, v24
  v_dot2_f32_bf16 v24, v90, v6, v24
  v_dot2_f32_bf16 v24, v91, v7, v24
  s_cbranch_vccnz L_w24
  s_waitcnt vmcnt(4)
L_w24:
  s_waitcnt vmcnt(6)
  buffer_load_dwordx4 v[56:59], v191, s[12:15], s6 offen offset:2048 nt
  v_dot2_f32_bf16 v25, v92, v4, 0
  v_dot2_f32_bf16 v25, v93, v5, v25
  v_dot2_f32_bf16 v25, v94, v6, v25
  v_dot2_f32_bf16 v25, v95, v7, v25
  v_add_f32_dpp v18, v18, v18 row_ror:8 row_mask:0xf bank_mask:0x3
  v_add_f32_dpp v20, v20, v20 row_ror:8 row_mask:0xf bank_mask:0x3
  v_add_f32_dpp v22, v22, v22 row_ror:8 row_mask:0xf bank_mask:0x3
  v_add_f32_dpp v24, v24, v24 row_ror:8 row_mask:0xf bank_mask:0x3
  v_add_f32_dpp v18, v19, v19 row_ror:8 row_mask:0xf bank_mask:0xc
  v_add_f32_dpp v20, v21, v21 row_ror:8 row_mask:0xf bank_mask:0xc
  v_add_f32_dpp v22, v23, v23 row_ror:8 row_mask:0xf bank_mask:0xc
  v_add_f32_dpp v24, v25, v25 row_ror:8 row_mask:0xf bank_mask:0xc
  v_add_f32_dpp v18, v18, v18 row_shl:4 row_mask:0xf bank_mask:0x5
  s_nop 0
  v_add_f32_dpp v22, v22, v22 row_shl:4 row_mask:0xf bank_mask:0x5
  v_add_f32_dpp v18, v20, v20 row_shr:4 row_mask:0xf bank_mask:0xa
  v_add_f32_dpp v22, v24, v24 row_shr:4 row_mask:0xf bank_mask:0xa
  s_nop 0
  v_add_f32_dpp v18, v18, v18 quad_perm:[2,3,0,1] row_mask:0xf bank_mask:0xf
  v_add_f32_dpp v22, v22, v22 quad_perm:[2,3,0,1] row_mask:0xf bank_mask:0xf
  v_cndmask_b32 v18, v18, v22, s[28:29]
  s_nop 1
  v_add_f32_dpp v18, v18, v18 quad_perm:[1,0,3,2] row_mask:0xf bank_mask:0xf
  ds_write_b32 v192, v18
  v_max_f32 v16, v16, v18
  v_add_u32 v192, 0x100, v192
  v_subrev_u32 v192, 8192, v192
  ds_read_b32 v193, v192
  v_add_u32 v192, 0x100, v192
  v_max_f32_dpp v16, v16, v16 quad_perm:[2,3,0,1] row_mask:0xf bank_mask:0xf
  s_nop 1
  v_max_f32_dpp v16, v16, v16 row_half_mirror row_mask:0xf bank_mask:0xf
  s_nop 1
  v_max_f32_dpp v16, v16, v16 row_mirror row_mask:0xf bank_mask:0xf
  s_nop 1
  v_mul_f32 v31, s16, v16
  s_mov_b32 s30, 14
L_loopv:
  s_cbranch_vccnz L_w25
  s_waitcnt vmcnt(4)
L_w25:
  s_waitcnt vmcnt(6)
  buffer_load_dwordx4 v[60:63], v191, s[12:15], s6 offen offset:3072 nt
  s_waitcnt lgkmcnt(0)
  v_fma_f32 v30, v193, s16, -v31
  v_exp_f32 v30, v30
  ds_read_b32 v193, v192
  v_add_u32 v192, 0x100, v192
  v_cvt_pk_bf16_f32 v22, v30, 0
  v_cvt_pk_bf16_f32 v26, 0, v30
  v_add_f32 v17, v17, v30
  s_nop 0
  v_dot2c_f32_bf16_dpp v8, v22, v32 row_newbcast:0 row_mask:0xf bank_mask:0xf
  v_dot2c_f32_bf16_dpp v9, v26, v32 row_newbcast:0 row_mask:0xf bank_mask:0xf
  v_dot2c_f32_bf16_dpp v10, v22, v33 row_newbcast:0 row_mask:0xf bank_mask:0xf
  v_dot2c_f32_bf16_dpp v11, v26, v33 row_newbcast:0 row_mask:0xf bank_mask:0xf
  v_dot2c_f32_bf16_dpp v12, v22, v34 row_newbcast:0 row_mask:0xf bank_mask:0xf
  v_dot2c_f32_bf16_dpp v13, v26, v34 row_newbcast:0 row_mask:0xf bank_mask:0xf
  v_dot2c_f32_bf16_dpp v14, v22, v35 row_newbcast:0 row_mask:0xf bank_mask:0xf
  v_dot2c_f32_bf16_dpp v15, v26, v35 row_newbcast:0 row_mask:0xf bank_mask:0xf
  ds_write_b32 v177, v0
  v_add_u32 v0, 4, v0
  s_or_b32 s6, s6, 4288806911
  s_add_u32 s6, s6, 1
  s_and_b32 s6, s6, 6160384
  s_or_b32 s6, s6, s32
  s_cbranch_vccnz L_w26
  s_waitcnt vmcnt(4)
L_w26:
  s_waitcnt vmcnt(6)
  buffer_load_dwordx4 v[64:67], v1, s[12:15], s6 offen offset:0 nt
  v_dot2c_f32_bf16_dpp v8, v22, v36 row_newbcast:8 row_mask:0xf bank_mask:0xf
  v_dot2c_f32_bf16_dpp v9, v26, v36 row_newbcast:8 row_mask:0xf bank_mask:0xf
  v_dot2c_f32_bf16_dpp v10, v22, v37 row_newbcast:8 row_mask:0xf bank_mask:0xf
  v_dot2c_f32_bf16_dpp v11, v26, v37 row_newbcast:8 row_mask:0xf bank_mask:0xf
  v_dot2c_f32_bf16_dpp v12, v22, v38 row_newbcast:8 row_mask:0xf bank_mask:0xf
  v_dot2c_f32_bf16_dpp v13, v26, v38 row_newbcast:8 row_mask:0xf bank_mask:0xf
  v_dot2c_f32_bf16_dpp v14, v22, v39 row_newbcast:8 row_mask:0xf bank_mask:0xf
  v_dot2c_f32_bf16_dpp v15, v26, v39 row_newbcast:8 row_mask:0xf bank_mask:0xf
  s_cbranch_vccnz L_w27
  s_waitcnt vmcnt(4)
L_w27:
  s_waitcnt vmcnt(6)
  buffer_load_dwordx4 v[68:71], v1, s[12:15], s6 offen offset:1024 nt
  v_dot2c_f32_bf16_dpp v8, v22, v40 row_newbcast:4 row_mask:0xf bank_mask:0xf
  v_dot2c_f32_bf16_dpp v9, v26, v40 row_newbcast:4 row_mask:0xf bank_mask:0xf
  v_dot2c_f32_bf16_dpp v10, v22, v41 row_newbcast:4 row_mask:0xf bank_mask:0xf
  v_dot2c_f32_bf16_dpp v11, v26, v41 row_newbcast:4 row_mask:0xf bank_mask:0xf
  v_dot2c_f32_bf16_dpp v12, v22, v42 row_newbcast:4 row_mask:0xf bank_mask:0xf
  v_dot2c_f32_bf16_dpp v13, v26, v42 row_newbcast:4 row_mask:0xf bank_mask:0xf
  v_dot2c_f32_bf16_dpp v14, v22, v43 row_newbcast:4 row_mask:0xf bank_mask:0xf
  v_dot2c_f32_bf16_dpp v15, v26, v43 row_newbcast:4 row_mask:0xf bank_mask:0xf
  ds_read_b64 v[196:197], v194
  s_cbranch_vccnz L_w28
  s_waitcnt vmcnt(4)
L_w28:
  s_waitcnt vmcnt(6)
  buffer_load_dwordx4 v[72:75], v1, s[12:15], s6 offen offset:2048 nt
  v_dot2c_f32_bf16_dpp v8, v22, v44 row_newbcast:12 row_mask:0xf bank_mask:0xf
  v_dot2c_f32_bf16_dpp v9, v26, v44 row_newbcast:12 row_mask:0xf bank_mask:0xf
  v_dot2c_f32_bf16_dpp v10, v22, v45 row_newbcast:12 row_mask:0xf bank_mask:0xf
  v_dot2c_f32_bf16_dpp v11, v26, v45 row_newbcast:12 row_mask:0xf bank_mask:0xf
  v_dot2c_f32_bf16_dpp v12, v22, v46 row_newbcast:12 row_mask:0xf bank_mask:0xf
  v_dot2c_f32_bf16_dpp v13, v26, v46 row_newbcast:12 row_mask:0xf bank_mask:0xf
  v_dot2c_f32_bf16_dpp v14, v22, v47 row_newbcast:12 row_mask:0xf bank_mask:0xf
  v_dot2c_f32_bf16_dpp v15, v26, v47 row_newbcast:12 row_mask:0xf bank_mask:0xf
  s_cbranch_vccnz L_w29
  s_waitcnt vmcnt(4)
L_w29:
  s_waitcnt vmcnt(6)
  buffer_load_dwordx4 v[76:79], v1, s[12:15], s6 offen offset:3072 nt
  v_dot2c_f32_bf16_dpp v8, v22, v48 row_newbcast:2 row_mask:0xf bank_mask:0xf
  v_dot2c_f32_bf16_dpp v9, v26, v48 row_newbcast:2 row_mask:0xf bank_mask:0xf
  v_dot2c_f32_bf16_dpp v10, v22, v49 row_newbcast:2 row_mask:0xf bank_mask:0xf
  v_dot2c_f32_bf16_dpp v11, v26, v49 row_newbcast:2 row_mask:0xf bank_mask:0xf
  v_dot2c_f32_bf16_dpp v12, v22, v50 row_newbcast:2 row_mask:0xf bank_mask:0xf
  v_dot2c_f32_bf16_dpp v13, v26, v50 row_newbcast:2 row_mask:0xf bank_mask:0xf
  v_dot2c_f32_bf16_dpp v14, v22, v51 row_newbcast:2 row_mask:0xf bank_mask:0xf
  v_dot2c_f32_bf16_dpp v15, v26, v51 row_newbcast:2 row_mask:0xf bank_mask:0xf
  s_memrealtime s[62:63]
  s_cbranch_vccnz L_w30
  s_waitcnt vmcnt(4)
L_w30:
  s_waitcnt vmcnt(6)
  buffer_load_dwordx4 v[80:83], v191, s[12:15], s6 offen offset:0 nt
  v_dot2c_f32_bf16_dpp v8, v22, v52 row_newbcast:10 row_mask:0xf bank_mask:0xf
  v_dot2c_f32_bf16_dpp v9, v26, v52 row_newbcast:10 row_mask:0xf bank_mask:0xf
  v_dot2c_f32_bf16_dpp v10, v22, v53 row_newbcast:10 row_mask:0xf bank_mask:0xf
  v_dot2c_f32_bf16_dpp v11, v26, v53 row_newbcast:10 row_mask:0xf bank_mask:0xf
  v_dot2c_f32_bf16_dpp v12, v22, v54 row_newbcast:10 row_mask:0xf bank_mask:0xf
  v_dot2c_f32_bf16_dpp v13, v26, v54 row_newbcast:10 row_mask:0xf bank_mask:0xf
  v_dot2c_f32_bf16_dpp v14, v22, v55 row_newbcast:10 row_mask:0xf bank_mask:0xf
  v_dot2c_f32_bf16_dpp v15, v26, v55 row_newbcast:10 row_mask:0xf bank_mask:0xf
  s_waitcnt lgkmcnt(0)
  s_lshl_b32 s62, s62, 6
  v_mad_u32_u24 v190, v0, v197, v196
  v_sub_u32 v190, s62, v190
  v_cmp_lt_i32 vcc, 0, v190
  s_cbranch_vccnz L_w31
  s_waitcnt vmcnt(4)
L_w31:
  s_waitcnt vmcnt(6)
  buffer_load_dwordx4 v[84:87], v191, s[12:15], s6 offen offset:1024 nt
  v_dot2c_f32_bf16_dpp v8, v22, v56 row_newbcast:6 row_mask:0xf bank_mask:0xf
  v_dot2c_f32_bf16_dpp v9, v26, v56 row_newbcast:6 row_mask:0xf bank_mask:0xf
  v_dot2c_f32_bf16_dpp v10, v22, v57 row_newbcast:6 row_mask:0xf bank_mask:0xf
  v_dot2c_f32_bf16_dpp v11, v26, v57 row_newbcast:6 row_mask:0xf bank_mask:0xf
  v_dot2c_f32_bf16_dpp v12, v22, v58 row_newbcast:6 row_mask:0xf bank_mask:0xf
  v_dot2c_f32_bf16_dpp v13, v26, v58 row_newbcast:6 row_mask:0xf bank_mask:0xf
  v_dot2c_f32_bf16_dpp v14, v22, v59 row_newbcast:6 row_mask:0xf bank_mask:0xf
  v_dot2c_f32_bf16_dpp v15, v26, v59 row_newbcast:6 row_mask:0xf bank_mask:0xf
  s_cbranch_vccnz L_w32
  s_waitcnt vmcnt(4)
L_w32:
  s_waitcnt vmcnt(6)
  buffer_load_dwordx4 v[88:91], v191, s[12:15], s6 offen offset:2048 nt
  v_dot2c_f32_bf16_dpp v8, v22, v60 row_newbcast:14 row_mask:0xf bank_mask:0xf
  v_dot2c_f32_bf16_dpp v9, v26, v60 row_newbcast:14 row_mask:0xf bank_mask:0xf
  v_dot2c_f32_bf16_dpp v10, v22, v61 row_newbcast:14 row_mask:0xf bank_mask:0xf
  v_dot2c_f32_bf16_dpp v11, v26, v61 row_newbcast:14 row_mask:0xf bank_mask:0xf
  v_dot2c_f32_bf16_dpp v12, v22, v62 row_newbcast:14 row_mask:0xf bank_mask:0xf
  v_dot2c_f32_bf16_dpp v13, v26, v62 row_newbcast:14 row_mask:0xf bank_mask:0xf
  v_dot2c_f32_bf16_dpp v14, v22, v63 row_newbcast:14 row_mask:0xf bank_mask:0xf
  v_dot2c_f32_bf16_dpp v15, v26, v63 row_newbcast:14 row_mask:0xf bank_mask:0xf
  s_cbranch_vccnz L_w33
  s_waitcnt vmcnt(4)
L_w33:
  s_waitcnt vmcnt(6)
  buffer_load_dwordx4 v[92:95], v191, s[12:15], s6 offen offset:3072 nt
  s_waitcnt lgkmcnt(0)
  v_fma_f32 v30, v193, s16, -v31
  v_exp_f32 v30, v30
  ds_read_b32 v193, v192
  v_add_u32 v192, 0x100, v192
  v_cvt_pk_bf16_f32 v22, v30, 0
  v_cvt_pk_bf16_f32 v26, 0, v30
  v_add_f32 v17, v17, v30
  s_nop 0
  v_dot2c_f32_bf16_dpp v8, v22, v64 row_newbcast:0 row_mask:0xf bank_mask:0xf
  v_dot2c_f32_bf16_dpp v9, v26, v64 row_newbcast:0 row_mask:0xf bank_mask:0xf
  v_dot2c_f32_bf16_dpp v10, v22, v65 row_newbcast:0 row_mask:0xf bank_mask:0xf
  v_dot2c_f32_bf16_dpp v11, v26, v65 row_newbcast:0 row_mask:0xf bank_mask:0xf
  v_dot2c_f32_bf16_dpp v12, v22, v66 row_newbcast:0 row_mask:0xf bank_mask:0xf
  v_dot2c_f32_bf16_dpp v13, v26, v66 row_newbcast:0 row_mask:0xf bank_mask:0xf
  v_dot2c_f32_bf16_dpp v14, v22, v67 row_newbcast:0 row_mask:0xf bank_mask:0xf
  v_dot2c_f32_bf16_dpp v15, v26, v67 row_newbcast:0 row_mask:0xf bank_mask:0xf
  ds_write_b32 v177, v0
  v_add_u32 v0, 4, v0
  s_or_b32 s6, s6, 4288806911
  s_add_u32 s6, s6, 1
  s_and_b32 s6, s6, 6160384
  s_or_b32 s6, s6, s32
  s_cbranch_vccnz L_w34
  s_waitcnt vmcnt(4)
L_w34:
  s_waitcnt vmcnt(6)
  buffer_load_dwordx4 v[32:35], v1, s[12:15], s6 offen offset:0 nt
  v_dot2c_f32_bf16_dpp v8, v22, v68 row_newbcast:8 row_mask:0xf bank_mask:0xf
  v_dot2c_f32_bf16_dpp v9, v26, v68 row_newbcast:8 row_mask:0xf bank_mask:0xf
  v_dot2c_f32_bf16_dpp v10, v22, v69 row_newbcast:8 row_mask:0xf bank_mask:0xf
  v_dot2c_f32_bf16_dpp v11, v26, v69 row_newbcast:8 row_mask:0xf bank_mask:0xf
  v_dot2c_f32_bf16_dpp v12, v22, v70 row_newbcast:8 row_mask:0xf bank_mask:0xf
  v_dot2c_f32_bf16_dpp v13, v26, v70 row_newbcast:8 row_mask:0xf bank_mask:0xf
  v_dot2c_f32_bf16_dpp v14, v22, v71 row_newbcast:8 row_mask:0xf bank_mask:0xf
  v_dot2c_f32_bf16_dpp v15, v26, v71 row_newbcast:8 row_mask:0xf bank_mask:0xf
  s_cbranch_vccnz L_w35
  s_waitcnt vmcnt(4)
L_w35:
  s_waitcnt vmcnt(6)
  buffer_load_dwordx4 v[36:39], v1, s[12:15], s6 offen offset:1024 nt
  v_dot2c_f32_bf16_dpp v8, v22, v72 row_newbcast:4 row_mask:0xf bank_mask:0xf
  v_dot2c_f32_bf16_dpp v9, v26, v72 row_newbcast:4 row_mask:0xf bank_mask:0xf
  v_dot2c_f32_bf16_dpp v10, v22, v73 row_newbcast:4 row_mask:0xf bank_mask:0xf
  v_dot2c_f32_bf16_dpp v11, v26, v73 row_newbcast:4 row_mask:0xf bank_mask:0xf
  v_dot2c_f32_bf16_dpp v12, v22, v74 row_newbcast:4 row_mask:0xf bank_mask:0xf
  v_dot2c_f32_bf16_dpp v13, v26, v74 row_newbcast:4 row_mask:0xf bank_mask:0xf
  v_dot2c_f32_bf16_dpp v14, v22, v75 row_newbcast:4 row_mask:0xf bank_mask:0xf
  v_dot2c_f32_bf16_dpp v15, v26, v75 row_newbcast:4 row_mask:0xf bank_mask:0xf
  ds_read_b64 v[196:197], v194
  s_cbranch_vccnz L_w36
  s_waitcnt vmcnt(4)
L_w36:
  s_waitcnt vmcnt(6)
  buffer_load_dwordx4 v[40:43], v1, s[12:15], s6 offen offset:2048 nt
  v_dot2c_f32_bf16_dpp v8, v22, v76 row_newbcast:12 row_mask:0xf bank_mask:0xf
  v_dot2c_f32_bf16_dpp v9, v26, v76 row_newbcast:12 row_mask:0xf bank_mask:0xf
  v_dot2c_f32_bf16_dpp v10, v22, v77 row_newbcast:12 row_mask:0xf bank_mask:0xf
  v_dot2c_f32_bf16_dpp v11, v26, v77 row_newbcast:12 row_mask:0xf bank_mask:0xf
  v_dot2c_f32_bf16_dpp v12, v22, v78 row_newbcast:12 row_mask:0xf bank_mask:0xf
  v_dot2c_f32_bf16_dpp v13, v26, v78 row_newbcast:12 row_mask:0xf bank_mask:0xf
  v_dot2c_f32_bf16_dpp v14, v22, v79 row_newbcast:12 row_mask:0xf bank_mask:0xf
  v_dot2c_f32_bf16_dpp v15, v26, v79 row_newbcast:12 row_mask:0xf bank_mask:0xf
  s_cbranch_vccnz L_w37
  s_waitcnt vmcnt(4)
L_w37:
  s_waitcnt vmcnt(6)
  buffer_load_dwordx4 v[44:47], v1, s[12:15], s6 offen offset:3072 nt
  v_dot2c_f32_bf16_dpp v8, v22, v80 row_newbcast:2 row_mask:0xf bank_mask:0xf
  v_dot2c_f32_bf16_dpp v9, v26, v80 row_newbcast:2 row_mask:0xf bank_mask:0xf
  v_dot2c_f32_bf16_dpp v10, v22, v81 row_newbcast:2 row_mask:0xf bank_mask:0xf
  v_dot2c_f32_bf16_dpp v11, v26, v81 row_newbcast:2 row_mask:0xf bank_mask:0xf
  v_dot2c_f32_bf16_dpp v12, v22, v82 row_newbcast:2 row_mask:0xf bank_mask:0xf
  v_dot2c_f32_bf16_dpp v13, v26, v82 row_newbcast:2 row_mask:0xf bank_mask:0xf
  v_dot2c_f32_bf16_dpp v14, v22, v83 row_newbcast:2 row_mask:0xf bank_mask:0xf
  v_dot2c_f32_bf16_dpp v15, v26, v83 row_newbcast:2 row_mask:0xf bank_mask:0xf
  s_memrealtime s[62:63]
  s_cbranch_vccnz L_w38
  s_waitcnt vmcnt(4)
L_w38:
  s_waitcnt vmcnt(6)
  buffer_load_dwordx4 v[48:51], v191, s[12:15], s6 offen offset:0 nt
  v_dot2c_f32_bf16_dpp v8, v22, v84 row_newbcast:10 row_mask:0xf bank_mask:0xf
  v_dot2c_f32_bf16_dpp v9, v26, v84 row_newbcast:10 row_mask:0xf bank_mask:0xf
  v_dot2c_f32_bf16_dpp v10, v22, v85 row_newbcast:10 row_mask:0xf bank_mask:0xf
  v_dot2c_f32_bf16_dpp v11, v26, v85 row_newbcast:10 row_mask:0xf bank_mask:0xf
  v_dot2c_f32_bf16_dpp v12, v22, v86 row_newbcast:10 row_mask:0xf bank_mask:0xf
  v_dot2c_f32_bf16_dpp v13, v26, v86 row_newbcast:10 row_mask:0xf bank_mask:0xf
  v_dot2c_f32_bf16_dpp v14, v22, v87 row_newbcast:10 row_mask:0xf bank_mask:0xf
  v_dot2c_f32_bf16_dpp v15, v26, v87 row_newbcast:10 row_mask:0xf bank_mask:0xf
  s_waitcnt lgkmcnt(0)
  s_lshl_b32 s62, s62, 6
  v_mad_u32_u24 v190, v0, v197, v196
  v_sub_u32 v190, s62, v190
  v_cmp_lt_i32 vcc, 0, v190
  s_cbranch_vccnz L_w39
  s_waitcnt vmcnt(4)
L_w39:
  s_waitcnt vmcnt(6)
  buffer_load_dwordx4 v[52:55], v191, s[12:15], s6 offen offset:1024 nt
  v_dot2c_f32_bf16_dpp v8, v22, v88 row_newbcast:6 row_mask:0xf bank_mask:0xf
  v_dot2c_f32_bf16_dpp v9, v26, v88 row_newbcast:6 row_mask:0xf bank_mask:0xf
  v_dot2c_f32_bf16_dpp v10, v22, v89 row_newbcast:6 row_mask:0xf bank_mask:0xf
  v_dot2c_f32_bf16_dpp v11, v26, v89 row_newbcast:6 row_mask:0xf bank_mask:0xf
  v_dot2c_f32_bf16_dpp v12, v22, v90 row_newbcast:6 row_mask:0xf bank_mask:0xf
  v_dot2c_f32_bf16_dpp v13, v26, v90 row_newbcast:6 row_mask:0xf bank_mask:0xf
  v_dot2c_f32_bf16_dpp v14, v22, v91 row_newbcast:6 row_mask:0xf bank_mask:0xf
  v_dot2c_f32_bf16_dpp v15, v26, v91 row_newbcast:6 row_mask:0xf bank_mask:0xf
  s_cbranch_vccnz L_w40
  s_waitcnt vmcnt(4)
L_w40:
  s_waitcnt vmcnt(6)
  buffer_load_dwordx4 v[56:59], v191, s[12:15], s6 offen offset:2048 nt
  v_dot2c_f32_bf16_dpp v8, v22, v92 row_newbcast:14 row_mask:0xf bank_mask:0xf
  v_dot2c_f32_bf16_dpp v9, v26, v92 row_newbcast:14 row_mask:0xf bank_mask:0xf
  v_dot2c_f32_bf16_dpp v10, v22, v93 row_newbcast:14 row_mask:0xf bank_mask:0xf
  v_dot2c_f32_bf16_dpp v11, v26, v93 row_newbcast:14 row_mask:0xf bank_mask:0xf
  v_dot2c_f32_bf16_dpp v12, v22, v94 row_newbcast:14 row_mask:0xf bank_mask:0xf
  v_dot2c_f32_bf16_dpp v13, v26, v94 row_newbcast:14 row_mask:0xf bank_mask:0xf
  v_dot2c_f32_bf16_dpp v14, v22, v95 row_newbcast:14 row_mask:0xf bank_mask:0xf
  v_dot2c_f32_bf16_dpp v15, v26, v95 row_newbcast:14 row_mask:0xf bank_mask:0xf
  s_sub_u32 s30, s30, 1
  s_cbranch_scc1 L_lastv
  s_branch L_loopv
L_lastv:
  s_cbranch_vccnz L_w41
  s_waitcnt vmcnt(4)
L_w41:
  s_waitcnt vmcnt(6)
  buffer_load_dwordx4 v[60:63], v191, s[12:15], s6 offen offset:3072 nt
  s_waitcnt lgkmcnt(0)
  v_fma_f32 v30, v193, s16, -v31
  v_exp_f32 v30, v30
  ds_read_b32 v193, v192
  v_add_u32 v192, 0x100, v192
  v_cvt_pk_bf16_f32 v22, v30, 0
  v_cvt_pk_bf16_f32 v26, 0, v30
  v_add_f32 v17, v17, v30
  s_nop 0
  v_dot2c_f32_bf16_dpp v8, v22, v32 row_newbcast:0 row_mask:0xf bank_mask:0xf
  v_dot2c_f32_bf16_dpp v9, v26, v32 row_newbcast:0 row_mask:0xf bank_mask:0xf
  v_dot2c_f32_bf16_dpp v10, v22, v33 row_newbcast:0 row_mask:0xf bank_mask:0xf
  v_dot2c_f32_bf16_dpp v11, v26, v33 row_newbcast:0 row_mask:0xf bank_mask:0xf
  v_dot2c_f32_bf16_dpp v12, v22, v34 row_newbcast:0 row_mask:0xf bank_mask:0xf
  v_dot2c_f32_bf16_dpp v13, v26, v34 row_newbcast:0 row_mask:0xf bank_mask:0xf
  v_dot2c_f32_bf16_dpp v14, v22, v35 row_newbcast:0 row_mask:0xf bank_mask:0xf
  v_dot2c_f32_bf16_dpp v15, v26, v35 row_newbcast:0 row_mask:0xf bank_mask:0xf
  ds_write_b32 v177, v0
  v_add_u32 v0, 4, v0
  ds_write_b32 v177, v0
  v_add_u32 v0, 4, v0
  s_or_b32 s6, s6, 4288806911
  s_add_u32 s6, s6, 1
  s_and_b32 s6, s6, 6160384
  s_or_b32 s6, s6, s32
  s_waitcnt vmcnt(6)
  buffer_load_dwordx4 v[64:67], v1, s[12:15], s6 offen offset:0 nt
  buffer_load_dwordx4 v[68:71], v1, s[12:15], s6 offen offset:1024 nt
  buffer_load_dwordx4 v[72:75], v1, s[12:15], s6 offen offset:2048 nt
  buffer_load_dwordx4 v[76:79], v1, s[12:15], s6 offen offset:3072 nt
  buffer_load_dwordx4 v[80:83], v191, s[12:15], s6 offen offset:0 nt
  buffer_load_dwordx4 v[84:87], v191, s[12:15], s6 offen offset:1024 nt
  buffer_load_dwordx4 v[88:91], v191, s[12:15], s6 offen offset:2048 nt
  buffer_load_dwordx4 v[92:95], v191, s[12:15], s6 offen offset:3072 nt
  v_dot2c_f32_bf16_dpp v8, v22, v36 row_newbcast:8 row_mask:0xf bank_mask:0xf
  v_dot2c_f32_bf16_dpp v9, v26, v36 row_newbcast:8 row_mask:0xf bank_mask:0xf
  v_dot2c_f32_bf16_dpp v10, v22, v37 row_newbcast:8 row_mask:0xf bank_mask:0xf
  v_dot2c_f32_bf16_dpp v11, v26, v37 row_newbcast:8 row_mask:0xf bank_mask:0xf
  v_dot2c_f32_bf16_dpp v12, v22, v38 row_newbcast:8 row_mask:0xf bank_mask:0xf
  v_dot2c_f32_bf16_dpp v13, v26, v38 row_newbcast:8 row_mask:0xf bank_mask:0xf
  v_dot2c_f32_bf16_dpp v14, v22, v39 row_newbcast:8 row_mask:0xf bank_mask:0xf
  v_dot2c_f32_bf16_dpp v15, v26, v39 row_newbcast:8 row_mask:0xf bank_mask:0xf
  s_waitcnt vmcnt(13)
  v_dot2c_f32_bf16_dpp v8, v22, v40 row_newbcast:4 row_mask:0xf bank_mask:0xf
  v_dot2c_f32_bf16_dpp v9, v26, v40 row_newbcast:4 row_mask:0xf bank_mask:0xf
  v_dot2c_f32_bf16_dpp v10, v22, v41 row_newbcast:4 row_mask:0xf bank_mask:0xf
  v_dot2c_f32_bf16_dpp v11, v26, v41 row_newbcast:4 row_mask:0xf bank_mask:0xf
  v_dot2c_f32_bf16_dpp v12, v22, v42 row_newbcast:4 row_mask:0xf bank_mask:0xf
  v_dot2c_f32_bf16_dpp v13, v26, v42 row_newbcast:4 row_mask:0xf bank_mask:0xf
  v_dot2c_f32_bf16_dpp v14, v22, v43 row_newbcast:4 row_mask:0xf bank_mask:0xf
  v_dot2c_f32_bf16_dpp v15, v26, v43 row_newbcast:4 row_mask:0xf bank_mask:0xf
  s_waitcnt vmcnt(12)
  v_dot2c_f32_bf16_dpp v8, v22, v44 row_newbcast:12 row_mask:0xf bank_mask:0xf
  v_dot2c_f32_bf16_dpp v9, v26, v44 row_newbcast:12 row_mask:0xf bank_mask:0xf
  v_dot2c_f32_bf16_dpp v10, v22, v45 row_newbcast:12 row_mask:0xf bank_mask:0xf
  v_dot2c_f32_bf16_dpp v11, v26, v45 row_newbcast:12 row_mask:0xf bank_mask:0xf
  v_dot2c_f32_bf16_dpp v12, v22, v46 row_newbcast:12 row_mask:0xf bank_mask:0xf
  v_dot2c_f32_bf16_dpp v13, v26, v46 row_newbcast:12 row_mask:0xf bank_mask:0xf
  v_dot2c_f32_bf16_dpp v14, v22, v47 row_newbcast:12 row_mask:0xf bank_mask:0xf
  v_dot2c_f32_bf16_dpp v15, v26, v47 row_newbcast:12 row_mask:0xf bank_mask:0xf
  s_waitcnt vmcnt(11)
  v_dot2c_f32_bf16_dpp v8, v22, v48 row_newbcast:2 row_mask:0xf bank_mask:0xf
  v_dot2c_f32_bf16_dpp v9, v26, v48 row_newbcast:2 row_mask:0xf bank_mask:0xf
  v_dot2c_f32_bf16_dpp v10, v22, v49 row_newbcast:2 row_mask:0xf bank_mask:0xf
  v_dot2c_f32_bf16_dpp v11, v26, v49 row_newbcast:2 row_mask:0xf bank_mask:0xf
  v_dot2c_f32_bf16_dpp v12, v22, v50 row_newbcast:2 row_mask:0xf bank_mask:0xf
  v_dot2c_f32_bf16_dpp v13, v26, v50 row_newbcast:2 row_mask:0xf bank_mask:0xf
  v_dot2c_f32_bf16_dpp v14, v22, v51 row_newbcast:2 row_mask:0xf bank_mask:0xf
  v_dot2c_f32_bf16_dpp v15, v26, v51 row_newbcast:2 row_mask:0xf bank_mask:0xf
  s_waitcnt vmcnt(10)
  v_dot2c_f32_bf16_dpp v8, v22, v52 row_newbcast:10 row_mask:0xf bank_mask:0xf
  v_dot2c_f32_bf16_dpp v9, v26, v52 row_newbcast:10 row_mask:0xf bank_mask:0xf
  v_dot2c_f32_bf16_dpp v10, v22, v53 row_newbcast:10 row_mask:0xf bank_mask:0xf
  v_dot2c_f32_bf16_dpp v11, v26, v53 row_newbcast:10 row_mask:0xf bank_mask:0xf
  v_dot2c_f32_bf16_dpp v12, v22, v54 row_newbcast:10 row_mask:0xf bank_mask:0xf
  v_dot2c_f32_bf16_dpp v13, v26, v54 row_newbcast:10 row_mask:0xf bank_mask:0xf
  v_dot2c_f32_bf16_dpp v14, v22, v55 row_newbcast:10 row_mask:0xf bank_mask:0xf
  v_dot2c_f32_bf16_dpp v15, v26, v55 row_newbcast:10 row_mask:0xf bank_mask:0xf
  s_waitcnt vmcnt(9)
  v_dot2c_f32_bf16_dpp v8, v22, v56 row_newbcast:6 row_mask:0xf bank_mask:0xf
  v_dot2c_f32_bf16_dpp v9, v26, v56 row_newbcast:6 row_mask:0xf bank_mask:0xf
  v_dot2c_f32_bf16_dpp v10, v22, v57 row_newbcast:6 row_mask:0xf bank_mask:0xf
  v_dot2c_f32_bf16_dpp v11, v26, v57 row_newbcast:6 row_mask:0xf bank_mask:0xf
  v_dot2c_f32_bf16_dpp v12, v22, v58 row_newbcast:6 row_mask:0xf bank_mask:0xf
  v_dot2c_f32_bf16_dpp v13, v26, v58 row_newbcast:6 row_mask:0xf bank_mask:0xf
  v_dot2c_f32_bf16_dpp v14, v22, v59 row_newbcast:6 row_mask:0xf bank_mask:0xf
  v_dot2c_f32_bf16_dpp v15, v26, v59 row_newbcast:6 row_mask:0xf bank_mask:0xf
  s_waitcnt vmcnt(8)
  v_dot2c_f32_bf16_dpp v8, v22, v60 row_newbcast:14 row_mask:0xf bank_mask:0xf
  v_dot2c_f32_bf16_dpp v9, v26, v60 row_newbcast:14 row_mask:0xf bank_mask:0xf
  v_dot2c_f32_bf16_dpp v10, v22, v61 row_newbcast:14 row_mask:0xf bank_mask:0xf
  v_dot2c_f32_bf16_dpp v11, v26, v61 row_newbcast:14 row_mask:0xf bank_mask:0xf
  v_dot2c_f32_bf16_dpp v12, v22, v62 row_newbcast:14 row_mask:0xf bank_mask:0xf
  v_dot2c_f32_bf16_dpp v13, v26, v62 row_newbcast:14 row_mask:0xf bank_mask:0xf
  v_dot2c_f32_bf16_dpp v14, v22, v63 row_newbcast:14 row_mask:0xf bank_mask:0xf
  v_dot2c_f32_bf16_dpp v15, v26, v63 row_newbcast:14 row_mask:0xf bank_mask:0xf
  s_waitcnt vmcnt(7)
  s_waitcnt lgkmcnt(0)
  v_fma_f32 v30, v193, s16, -v31
  v_exp_f32 v30, v30
  s_nop 0
  v_cvt_pk_bf16_f32 v22, v30, 0
  v_cvt_pk_bf16_f32 v26, 0, v30
  v_add_f32 v17, v17, v30
  s_nop 0
  v_dot2c_f32_bf16_dpp v8, v22, v64 row_newbcast:0 row_mask:0xf bank_mask:0xf
  v_dot2c_f32_bf16_dpp v9, v26, v64 row_newbcast:0 row_mask:0xf bank_mask:0xf
  v_dot2c_f32_bf16_dpp v10, v22, v65 row_newbcast:0 row_mask:0xf bank_mask:0xf
  v_dot2c_f32_bf16_dpp v11, v26, v65 row_newbcast:0 row_mask:0xf bank_mask:0xf
  v_dot2c_f32_bf16_dpp v12, v22, v66 row_newbcast:0 row_mask:0xf bank_mask:0xf
  v_dot2c_f32_bf16_dpp v13, v26, v66 row_newbcast:0 row_mask:0xf bank_mask:0xf
  v_dot2c_f32_bf16_dpp v14, v22, v67 row_newbcast:0 row_mask:0xf bank_mask:0xf
  v_dot2c_f32_bf16_dpp v15, v26, v67 row_newbcast:0 row_mask:0xf bank_mask:0xf
  s_waitcnt vmcnt(6)
  v_dot2c_f32_bf16_dpp v8, v22, v68 row_newbcast:8 row_mask:0xf bank_mask:0xf
  v_dot2c_f32_bf16_dpp v9, v26, v68 row_newbcast:8 row_mask:0xf bank_mask:0xf
  v_dot2c_f32_bf16_dpp v10, v22, v69 row_newbcast:8 row_mask:0xf bank_mask:0xf
  v_dot2c_f32_bf16_dpp v11, v26, v69 row_newbcast:8 row_mask:0xf bank_mask:0xf
  v_dot2c_f32_bf16_dpp v12, v22, v70 row_newbcast:8 row_mask:0xf bank_mask:0xf
  v_dot2c_f32_bf16_dpp v13, v26, v70 row_newbcast:8 row_mask:0xf bank_mask:0xf
  v_dot2c_f32_bf16_dpp v14, v22, v71 row_newbcast:8 row_mask:0xf bank_mask:0xf
  v_dot2c_f32_bf16_dpp v15, v26, v71 row_newbcast:8 row_mask:0xf bank_mask:0xf
  v_add_f32_dpp v17, v17, v17 quad_perm:[2,3,0,1] row_mask:0xf bank_mask:0xf
  s_nop 1
  v_add_f32_dpp v17, v17, v17 row_half_mirror row_mask:0xf bank_mask:0xf
  s_nop 1
  v_add_f32_dpp v17, v17, v17 row_mirror row_mask:0xf bank_mask:0xf
  s_nop 1
  s_waitcnt vmcnt(5)
  v_dot2c_f32_bf16_dpp v8, v22, v72 row_newbcast:4 row_mask:0xf bank_mask:0xf
  v_dot2c_f32_bf16_dpp v9, v26, v72 row_newbcast:4 row_mask:0xf bank_mask:0xf
  v_dot2c_f32_bf16_dpp v10, v22, v73 row_newbcast:4 row_mask:0xf bank_mask:0xf
  v_dot2c_f32_bf16_dpp v11, v26, v73 row_newbcast:4 row_mask:0xf bank_mask:0xf
  v_dot2c_f32_bf16_dpp v12, v22, v74 row_newbcast:4 row_mask:0xf bank_mask:0xf
  v_dot2c_f32_bf16_dpp v13, v26, v74 row_newbcast:4 row_mask:0xf bank_mask:0xf
  v_dot2c_f32_bf16_dpp v14, v22, v75 row_newbcast:4 row_mask:0xf bank_mask:0xf
  v_dot2c_f32_bf16_dpp v15, v26, v75 row_newbcast:4 row_mask:0xf bank_mask:0xf
  s_waitcnt vmcnt(4)
  v_dot2c_f32_bf16_dpp v8, v22, v76 row_newbcast:12 row_mask:0xf bank_mask:0xf
  v_dot2c_f32_bf16_dpp v9, v26, v76 row_newbcast:12 row_mask:0xf bank_mask:0xf
  v_dot2c_f32_bf16_dpp v10, v22, v77 row_newbcast:12 row_mask:0xf bank_mask:0xf
  v_dot2c_f32_bf16_dpp v11, v26, v77 row_newbcast:12 row_mask:0xf bank_mask:0xf
  v_dot2c_f32_bf16_dpp v12, v22, v78 row_newbcast:12 row_mask:0xf bank_mask:0xf
  v_dot2c_f32_bf16_dpp v13, v26, v78 row_newbcast:12 row_mask:0xf bank_mask:0xf
  v_dot2c_f32_bf16_dpp v14, v22, v79 row_newbcast:12 row_mask:0xf bank_mask:0xf
  v_dot2c_f32_bf16_dpp v15, v26, v79 row_newbcast:12 row_mask:0xf bank_mask:0xf
  s_waitcnt vmcnt(3)
  v_dot2c_f32_bf16_dpp v8, v22, v80 row_newbcast:2 row_mask:0xf bank_mask:0xf
  v_dot2c_f32_bf16_dpp v9, v26, v80 row_newbcast:2 row_mask:0xf bank_mask:0xf
  v_dot2c_f32_bf16_dpp v10, v22, v81 row_newbcast:2 row_mask:0xf bank_mask:0xf
  v_dot2c_f32_bf16_dpp v11, v26, v81 row_newbcast:2 row_mask:0xf bank_mask:0xf
  v_dot2c_f32_bf16_dpp v12, v22, v82 row_newbcast:2 row_mask:0xf bank_mask:0xf
  v_dot2c_f32_bf16_dpp v13, v26, v82 row_newbcast:2 row_mask:0xf bank_mask:0xf
  v_dot2c_f32_bf16_dpp v14, v22, v83 row_newbcast:2 row_mask:0xf bank_mask:0xf
  v_dot2c_f32_bf16_dpp v15, v26, v83 row_newbcast:2 row_mask:0xf bank_mask:0xf
  s_waitcnt vmcnt(2)
  v_dot2c_f32_bf16_dpp v8, v22, v84 row_newbcast:10 row_mask:0xf bank_mask:0xf
  v_dot2c_f32_bf16_dpp v9, v26, v84 row_newbcast:10 row_mask:0xf bank_mask:0xf
  v_dot2c_f32_bf16_dpp v10, v22, v85 row_newbcast:10 row_mask:0xf bank_mask:0xf
  v_dot2c_f32_bf16_dpp v11, v26, v85 row_newbcast:10 row_mask:0xf bank_mask:0xf
  v_dot2c_f32_bf16_dpp v12, v22, v86 row_newbcast:10 row_mask:0xf bank_mask:0xf
  v_dot2c_f32_bf16_dpp v13, v26, v86 row_newbcast:10 row_mask:0xf bank_mask:0xf
  v_dot2c_f32_bf16_dpp v14, v22, v87 row_newbcast:10 row_mask:0xf bank_mask:0xf
  v_dot2c_f32_bf16_dpp v15, v26, v87 row_newbcast:10 row_mask:0xf bank_mask:0xf
  s_waitcnt vmcnt(1)
  v_dot2c_f32_bf16_dpp v8, v22, v88 row_newbcast:6 row_mask:0xf bank_mask:0xf
  v_dot2c_f32_bf16_dpp v9, v26, v88 row_newbcast:6 row_mask:0xf bank_mask:0xf
  v_dot2c_f32_bf16_dpp v10, v22, v89 row_newbcast:6 row_mask:0xf bank_mask:0xf
  v_dot2c_f32_bf16_dpp v11, v26, v89 row_newbcast:6 row_mask:0xf bank_mask:0xf
  v_dot2c_f32_bf16_dpp v12, v22, v90 row_newbcast:6 row_mask:0xf bank_mask:0xf
  v_dot2c_f32_bf16_dpp v13, v26, v90 row_newbcast:6 row_mask:0xf bank_mask:0xf
  v_dot2c_f32_bf16_dpp v14, v22, v91 row_newbcast:6 row_mask:0xf bank_mask:0xf
  v_dot2c_f32_bf16_dpp v15, v26, v91 row_newbcast:6 row_mask:0xf bank_mask:0xf
  s_waitcnt vmcnt(0)
  v_dot2c_f32_bf16_dpp v8, v22, v92 row_newbcast:14 row_mask:0xf bank_mask:0xf
  v_dot2c_f32_bf16_dpp v9, v26, v92 row_newbcast:14 row_mask:0xf bank_mask:0xf
  v_dot2c_f32_bf16_dpp v10, v22, v93 row_newbcast:14 row_mask:0xf bank_mask:0xf
  v_dot2c_f32_bf16_dpp v11, v26, v93 row_newbcast:14 row_mask:0xf bank_mask:0xf
  v_dot2c_f32_bf16_dpp v12, v22, v94 row_newbcast:14 row_mask:0xf bank_mask:0xf
  v_dot2c_f32_bf16_dpp v13, v26, v94 row_newbcast:14 row_mask:0xf bank_mask:0xf
  v_dot2c_f32_bf16_dpp v14, v22, v95 row_newbcast:14 row_mask:0xf bank_mask:0xf
  v_dot2c_f32_bf16_dpp v15, v26, v95 row_newbcast:14 row_mask:0xf bank_mask:0xf
  s_branch L_t1
L_ramp0:
  ds_read_b32 v176, v0
  ds_write_b32 v177, v0
  buffer_load_dwordx4 v[64:67], v1, s[8:11], s6 offen offset:0 nt
  buffer_load_dwordx4 v[68:71], v1, s[8:11], s6 offen offset:1024 nt
  buffer_load_dwordx4 v[72:75], v1, s[8:11], s6 offen offset:2048 nt
  buffer_load_dwordx4 v[76:79], v1, s[8:11], s6 offen offset:3072 nt
  buffer_load_dwordx4 v[80:83], v1, s[12:15], s6 offen offset:0 nt
  buffer_load_dwordx4 v[84:87], v1, s[12:15], s6 offen offset:1024 nt
  buffer_load_dwordx4 v[88:91], v1, s[12:15], s6 offen offset:2048 nt
  buffer_load_dwordx4 v[92:95], v1, s[12:15], s6 offen offset:3072 nt
  s_branch L_chk0
L_ramp1:
  ds_read_b32 v176, v0
  ds_write_b32 v177, v0
  buffer_load_dwordx4 v[32:35], v1, s[8:11], s6 offen offset:0 nt
  buffer_load_dwordx4 v[36:39], v1, s[8:11], s6 offen offset:1024 nt
  buffer_load_dwordx4 v[40:43], v1, s[8:11], s6 offen offset:2048 nt
  buffer_load_dwordx4 v[44:47], v1, s[8:11], s6 offen offset:3072 nt
  buffer_load_dwordx4 v[48:51], v1, s[12:15], s6 offen offset:0 nt
  buffer_load_dwordx4 v[52:55], v1, s[12:15], s6 offen offset:1024 nt
  buffer_load_dwordx4 v[56:59], v1, s[12:15], s6 offen offset:2048 nt
  buffer_load_dwordx4 v[60:63], v1, s[12:15], s6 offen offset:3072 nt
  s_branch L_chk1
L_loop:
  s_waitcnt vmcnt(14)
  buffer_load_dwordx4 v[92:95], v1, s[12:15], s6 offen offset:3072 nt
  ds_read_b32 v176, v0
  ds_write_b32 v177, v0
  v_dot2_f32_bf16 v18, v32, v4, 0
  v_dot2_f32_bf16 v18, v33, v5, v18
  v_dot2_f32_bf16 v18, v34, v6, v18
  v_dot2_f32_bf16 v18, v35, v7, v18
L_chk0:
  s_waitcnt lgkmcnt(0)
  v_readfirstlane_b32 s6, v176
  v_add_u32 v0, 4, v0
  s_waitcnt vmcnt(14)
  s_nop 0
  s_cmp_ge_u32 s6, -2
  s_cbranch_scc1 L_slowe0
L_back0:
  buffer_load_dwordx4 v[32:35], v1, s[8:11], s6 offen offset:0 nt
  v_dot2_f32_bf16 v19, v36, v4, 0
  v_dot2_f32_bf16 v19, v37, v5, v19
  v_dot2_f32_bf16 v19, v38, v6, v19
  v_dot2_f32_bf16 v19, v39, v7, v19
  s_waitcnt vmcnt(14)
  buffer_load_dwordx4 v[36:39], v1, s[8:11], s6 offen offset:1024 nt
  v_dot2_f32_bf16 v20, v40, v4, 0
  v_dot2_f32_bf16 v20, v41, v5, v20
  v_dot2_f32_bf16 v20, v42, v6, v20
  v_dot2_f32_bf16 v20, v43, v7, v20
  s_waitcnt vmcnt(14)
  buffer_load_dwordx4 v[40:43], v1, s[8:11], s6 offen offset:2048 nt
  v_dot2_f32_bf16 v21, v44, v4, 0
  v_dot2_f32_bf16 v21, v45, v5, v21
  v_dot2_f32_bf16 v21, v46, v6, v21
  v_dot2_f32_bf16 v21, v47, v7, v21
  v_add_f32_dpp v18, v18, v18 quad_perm:[1,0,3,2] row_mask:0xf bank_mask:0xf
  v_add_f32_dpp v19, v19, v19 quad_perm:[1,0,3,2] row_mask:0xf bank_mask:0xf
  v_add_f32_dpp v20, v20, v20 quad_perm:[1,0,3,2] row_mask:0xf bank_mask:0xf
  v_add_f32_dpp v21, v21, v21 quad_perm:[1,0,3,2] row_mask:0xf bank_mask:0xf
  v_add_f32_dpp v18, v18, v18 quad_perm:[2,3,0,1] row_mask:0xf bank_mask:0xf
  v_add_f32_dpp v19, v19, v19 quad_perm:[2,3,0,1] row_mask:0xf bank_mask:0xf
  v_add_f32_dpp v20, v20, v20 quad_perm:[2,3,0,1] row_mask:0xf bank_mask:0xf
  v_add_f32_dpp v21, v21, v21 quad_perm:[2,3,0,1] row_mask:0xf bank_mask:0xf
  v_add_f32_dpp v18, v18, v18 row_half_mirror row_mask:0xf bank_mask:0xf
  v_add_f32_dpp v19, v19, v19 row_half_mirror row_mask:0xf bank_mask:0xf
  v_add_f32_dpp v20, v20, v20 row_half_mirror row_mask:0xf bank_mask:0xf
  v_add_f32_dpp v21, v21, v21 row_half_mirror row_mask:0xf bank_mask:0xf
  v_add_f32_dpp v18, v18, v18 row_mirror row_mask:0xf bank_mask:0xf
  v_add_f32_dpp v19, v19, v19 row_mirror row_mask:0xf bank_mask:0xf
  v_add_f32_dpp v20, v20, v20 row_mirror row_mask:0xf bank_mask:0xf
  v_add_f32_dpp v21, v21, v21 row_mirror row_mask:0xf bank_mask:0xf
  v_max3_f32 v30, v18, v19, v16
  v_max3_f32 v30, v20, v21, v30
  v_sub_f32 v31, v16, v30
  v_mul_f32 v16, s16, v30
  v_mul_f32 v31, s16, v31
  v_fma_f32 v18, v18, s16, -v16
  v_fma_f32 v19, v19, s16, -v16
  v_fma_f32 v20, v20, s16, -v16
  v_fma_f32 v21, v21, s16, -v16
  v_exp_f32 v31, v31
  v_exp_f32 v18, v18
  v_exp_f32 v19, v19
  v_exp_f32 v20, v20
  v_exp_f32 v21, v21
  v_mov_b32 v16, v30
  v_mul_f32 v8, v31, v8
  v_mul_f32 v9, v31, v9
  v_mul_f32 v10, v31, v10
  v_mul_f32 v11, v31, v11
  v_mul_f32 v12, v31, v12
  v_mul_f32 v13, v31, v13
  v_mul_f32 v14, v31, v14
  v_mul_f32 v15, v31, v15
  v_mul_f32 v17, v31, v17
  v_cvt_pk_bf16_f32 v22, v18, 0
  v_cvt_pk_bf16_f32 v26, 0, v18
  v_cvt_pk_bf16_f32 v23, v19, 0
  v_cvt_pk_bf16_f32 v27, 0, v19
  v_cvt_pk_bf16_f32 v24, v20, 0
  v_cvt_pk_bf16_f32 v28, 0, v20
  v_cvt_pk_bf16_f32 v25, v21, 0
  v_cvt_pk_bf16_f32 v29, 0, v21
  v_add_f32 v30, v18, v19
  v_add_f32 v31, v20, v21
  v_add_f32 v17, v17, v30
  v_add_f32 v17, v17, v31
  s_waitcnt vmcnt(14)
  buffer_load_dwordx4 v[44:47], v1, s[8:11], s6 offen offset:3072 nt
  v_dot2c_f32_bf16 v8, v48, v22
  v_dot2c_f32_bf16 v9, v48, v26
  v_dot2c_f32_bf16 v10, v49, v22
  v_dot2c_f32_bf16 v11, v49, v26
  v_dot2c_f32_bf16 v12, v50, v22
  v_dot2c_f32_bf16 v13, v50, v26
  v_dot2c_f32_bf16 v14, v51, v22
  v_dot2c_f32_bf16 v15, v51, v26
  s_waitcnt vmcnt(14)
  buffer_load_dwordx4 v[48:51], v1, s[12:15], s6 offen offset:0 nt
  v_dot2c_f32_bf16 v8, v52, v23
  v_dot2c_f32_bf16 v9, v52, v27
  v_dot2c_f32_bf16 v10, v53, v23
  v_dot2c_f32_bf16 v11, v53, v27
  v_dot2c_f32_bf16 v12, v54, v23
  v_dot2c_f32_bf16 v13, v54, v27
  v_dot2c_f32_bf16 v14, v55, v23
  v_dot2c_f32_bf16 v15, v55, v27
  s_waitcnt vmcnt(14)
  buffer_load_dwordx4 v[52:55], v1, s[12:15], s6 offen offset:1024 nt
  v_dot2c_f32_bf16 v8, v56, v24
  v_dot2c_f32_bf16 v9, v56, v28
  v_dot2c_f32_bf16 v10, v57, v24
  v_dot2c_f32_bf16 v11, v57, v28
  v_dot2c_f32_bf16 v12, v58, v24
  v_dot2c_f32_bf16 v13, v58, v28
  v_dot2c_f32_bf16 v14, v59, v24
  v_dot2c_f32_bf16 v15, v59, v28
  s_waitcnt vmcnt(14)
  buffer_load_dwordx4 v[56:59], v1, s[12:15], s6 offen offset:2048 nt
  v_dot2c_f32_bf16 v8, v60, v25
  v_dot2c_f32_bf16 v9, v60, v29
  v_dot2c_f32_bf16 v10, v61, v25
  v_dot2c_f32_bf16 v11, v61, v29
  v_dot2c_f32_bf16 v12, v62, v25
  v_dot2c_f32_bf16 v13, v62, v29
  v_dot2c_f32_bf16 v14, v63, v25
  v_dot2c_f32_bf16 v15, v63, v29
  s_waitcnt vmcnt(14)
  buffer_load_dwordx4 v[60:63], v1, s[12:15], s6 offen offset:3072 nt
  ds_read_b32 v176, v0
  ds_write_b32 v177, v0
  v_dot2_f32_bf16 v18, v64, v4, 0
  v_dot2_f32_bf16 v18, v65, v5, v18
  v_dot2_f32_bf16 v18, v66, v6, v18
  v_dot2_f32_bf16 v18, v67, v7, v18
L_chk1:
  s_waitcnt lgkmcnt(0)
  v_readfirstlane_b32 s6, v176
  v_add_u32 v0, 4, v0
  s_waitcnt vmcnt(14)
  s_nop 0
  s_cmp_ge_u32 s6, -2
  s_cbranch_scc1 L_slowe1
L_back1:
  buffer_load_dwordx4 v[64:67], v1, s[8:11], s6 offen offset:0 nt
  v_dot2_f32_bf16 v19, v68, v4, 0
  v_dot2_f32_bf16 v19, v69, v5, v19
  v_dot2_f32_bf16 v19, v70, v6, v19
  v_dot2_f32_bf16 v19, v71, v7, v19
  s_waitcnt vmcnt(14)
  buffer_load_dwordx4 v[68:71], v1, s[8:11], s6 offen offset:1024 nt
  v_dot2_f32_bf16 v20, v72, v4, 0
  v_dot2_f32_bf16 v20, v73, v5, v20
  v_dot2_f32_bf16 v20, v74, v6, v20
  v_dot2_f32_bf16 v20, v75, v7, v20
  s_waitcnt vmcnt(14)
  buffer_load_dwordx4 v[72:75], v1, s[8:11], s6 offen offset:2048 nt
  v_dot2_f32_bf16 v21, v76, v4, 0
  v_dot2_f32_bf16 v21, v77, v5, v21
  v_dot2_f32_bf16 v21, v78, v6, v21
  v_dot2_f32_bf16 v21, v79, v7, v21
  v_add_f32_dpp v18, v18, v18 quad_perm:[1,0,3,2] row_mask:0xf bank_mask:0xf
  v_add_f32_dpp v19, v19, v19 quad_perm:[1,0,3,2] row_mask:0xf bank_mask:0xf
  v_add_f32_dpp v20, v20, v20 quad_perm:[1,0,3,2] row_mask:0xf bank_mask:0xf
  v_add_f32_dpp v21, v21, v21 quad_perm:[1,0,3,2] row_mask:0xf bank_mask:0xf
  v_add_f32_dpp v18, v18, v18 quad_perm:[2,3,0,1] row_mask:0xf bank_mask:0xf
  v_add_f32_dpp v19, v19, v19 quad_perm:[2,3,0,1] row_mask:0xf bank_mask:0xf
  v_add_f32_dpp v20, v20, v20 quad_perm:[2,3,0,1] row_mask:0xf bank_mask:0xf
  v_add_f32_dpp v21, v21, v21 quad_perm:[2,3,0,1] row_mask:0xf bank_mask:0xf
  v_add_f32_dpp v18, v18, v18 row_half_mirror row_mask:0xf bank_mask:0xf
  v_add_f32_dpp v19, v19, v19 row_half_mirror row_mask:0xf bank_mask:0xf
  v_add_f32_dpp v20, v20, v20 row_half_mirror row_mask:0xf bank_mask:0xf
  v_add_f32_dpp v21, v21, v21 row_half_mirror row_mask:0xf bank_mask:0xf
  v_add_f32_dpp v18, v18, v18 row_mirror row_mask:0xf bank_mask:0xf
  v_add_f32_dpp v19, v19, v19 row_mirror row_mask:0xf bank_mask:0xf
  v_add_f32_dpp v20, v20, v20 row_mirror row_mask:0xf bank_mask:0xf
  v_add_f32_dpp v21, v21, v21 row_mirror row_mask:0xf bank_mask:0xf
  v_max3_f32 v30, v18, v19, v16
  v_max3_f32 v30, v20, v21, v30
  v_sub_f32 v31, v16, v30
  v_mul_f32 v16, s16, v30
  v_mul_f32 v31, s16, v31
  v_fma_f32 v18, v18, s16, -v16
  v_fma_f32 v19, v19, s16, -v16
  v_fma_f32 v20, v20, s16, -v16
  v_fma_f32 v21, v21, s16, -v16
  v_exp_f32 v31, v31
  v_exp_f32 v18, v18
  v_exp_f32 v19, v19
  v_exp_f32 v20, v20
  v_exp_f32 v21, v21
  v_mov_b32 v16, v30
  v_mul_f32 v8, v31, v8
  v_mul_f32 v9, v31, v9
  v_mul_f32 v10, v31, v10
  v_mul_f32 v11, v31, v11
  v_mul_f32 v12, v31, v12
  v_mul_f32 v13, v31, v13
  v_mul_f32 v14, v31, v14
  v_mul_f32 v15, v31, v15
  v_mul_f32 v17, v31, v17
  v_cvt_pk_bf16_f32 v22, v18, 0
  v_cvt_pk_bf16_f32 v26, 0, v18
  v_cvt_pk_bf16_f32 v23, v19, 0
  v_cvt_pk_bf16_f32 v27, 0, v19
  v_cvt_pk_bf16_f32 v24, v20, 0
  v_cvt_pk_bf16_f32 v28, 0, v20
  v_cvt_pk_bf16_f32 v25, v21, 0
  v_cvt_pk_bf16_f32 v29, 0, v21
  v_add_f32 v30, v18, v19
  v_add_f32 v31, v20, v21
  v_add_f32 v17, v17, v30
  v_add_f32 v17, v17, v31
  s_waitcnt vmcnt(14)
  buffer_load_dwordx4 v[76:79], v1, s[8:11], s6 offen offset:3072 nt
  v_dot2c_f32_bf16 v8, v80, v22
  v_dot2c_f32_bf16 v9, v80, v26
  v_dot2c_f32_bf16 v10, v81, v22
  v_dot2c_f32_bf16 v11, v81, v26
  v_dot2c_f32_bf16 v12, v82, v22
  v_dot2c_f32_bf16 v13, v82, v26
  v_dot2c_f32_bf16 v14, v83, v22
  v_dot2c_f32_bf16 v15, v83, v26
  s_waitcnt vmcnt(14)
  buffer_load_dwordx4 v[80:83], v1, s[12:15], s6 offen offset:0 nt
  v_dot2c_f32_bf16 v8, v84, v23
  v_dot2c_f32_bf16 v9, v84, v27
  v_dot2c_f32_bf16 v10, v85, v23
  v_dot2c_f32_bf16 v11, v85, v27
  v_dot2c_f32_bf16 v12, v86, v23
  v_dot2c_f32_bf16 v13, v86, v27
  v_dot2c_f32_bf16 v14, v87, v23
  v_dot2c_f32_bf16 v15, v87, v27
  s_waitcnt vmcnt(14)
  buffer_load_dwordx4 v[84:87], v1, s[12:15], s6 offen offset:1024 nt
  v_dot2c_f32_bf16 v8, v88, v24
  v_dot2c_f32_bf16 v9, v88, v28
  v_dot2c_f32_bf16 v10, v89, v24
  v_dot2c_f32_bf16 v11, v89, v28
  v_dot2c_f32_bf16 v12, v90, v24
  v_dot2c_f32_bf16 v13, v90, v28
  v_dot2c_f32_bf16 v14, v91, v24
  v_dot2c_f32_bf16 v15, v91, v28
  s_waitcnt vmcnt(14)
  buffer_load_dwordx4 v[88:91], v1, s[12:15], s6 offen offset:2048 nt
  v_dot2c_f32_bf16 v8, v92, v25
  v_dot2c_f32_bf16 v9, v92, v29
  v_dot2c_f32_bf16 v10, v93, v25
  v_dot2c_f32_bf16 v11, v93, v29
  v_dot2c_f32_bf16 v12, v94, v25
  v_dot2c_f32_bf16 v13, v94, v29
  v_dot2c_f32_bf16 v14, v95, v25
  v_dot2c_f32_bf16 v15, v95, v29
  s_branch L_loop
L_slowe1:
  s_waitcnt vmcnt(14)
  v_dot2_f32_bf16 v19, v68, v4, 0
  v_dot2_f32_bf16 v19, v69, v5, v19
  v_dot2_f32_bf16 v19, v70, v6, v19
  v_dot2_f32_bf16 v19, v71, v7, v19
  s_waitcnt vmcnt(13)
  v_dot2_f32_bf16 v20, v72, v4, 0
  v_dot2_f32_bf16 v20, v73, v5, v20
  v_dot2_f32_bf16 v20, v74, v6, v20
  v_dot2_f32_bf16 v20, v75, v7, v20
  s_waitcnt vmcnt(12)
  v_dot2_f32_bf16 v21, v76, v4, 0
  v_dot2_f32_bf16 v21, v77, v5, v21
  v_dot2_f32_bf16 v21, v78, v6, v21
  v_dot2_f32_bf16 v21, v79, v7, v21
  v_add_f32_dpp v18, v18, v18 quad_perm:[1,0,3,2] row_mask:0xf bank_mask:0xf
  v_add_f32_dpp v19, v19, v19 quad_perm:[1,0,3,2] row_mask:0xf bank_mask:0xf
  v_add_f32_dpp v20, v20, v20 quad_perm:[1,0,3,2] row_mask:0xf bank_mask:0xf
  v_add_f32_dpp v21, v21, v21 quad_perm:[1,0,3,2] row_mask:0xf bank_mask:0xf
  v_add_f32_dpp v18, v18, v18 quad_perm:[2,3,0,1] row_mask:0xf bank_mask:0xf
  v_add_f32_dpp v19, v19, v19 quad_perm:[2,3,0,1] row_mask:0xf bank_mask:0xf
  v_add_f32_dpp v20, v20, v20 quad_perm:[2,3,0,1] row_mask:0xf bank_mask:0xf
  v_add_f32_dpp v21, v21, v21 quad_perm:[2,3,0,1] row_mask:0xf bank_mask:0xf
  v_add_f32_dpp v18, v18, v18 row_half_mirror row_mask:0xf bank_mask:0xf
  v_add_f32_dpp v19, v19, v19 row_half_mirror row_mask:0xf bank_mask:0xf
  v_add_f32_dpp v20, v20, v20 row_half_mirror row_mask:0xf bank_mask:0xf
  v_add_f32_dpp v21, v21, v21 row_half_mirror row_mask:0xf bank_mask:0xf
  v_add_f32_dpp v18, v18, v18 row_mirror row_mask:0xf bank_mask:0xf
  v_add_f32_dpp v19, v19, v19 row_mirror row_mask:0xf bank_mask:0xf
  v_add_f32_dpp v20, v20, v20 row_mirror row_mask:0xf bank_mask:0xf
  v_add_f32_dpp v21, v21, v21 row_mirror row_mask:0xf bank_mask:0xf
  v_max3_f32 v30, v18, v19, v16
  v_max3_f32 v30, v20, v21, v30
  v_sub_f32 v31, v16, v30
  v_mul_f32 v16, s16, v30
  v_mul_f32 v31, s16, v31
  v_fma_f32 v18, v18, s16, -v16
  v_fma_f32 v19, v19, s16, -v16
  v_fma_f32 v20, v20, s16, -v16
  v_fma_f32 v21, v21, s16, -v16
  v_exp_f32 v31, v31
  v_exp_f32 v18, v18
  v_exp_f32 v19, v19
  v_exp_f32 v20, v20
  v_exp_f32 v21, v21
  v_mov_b32 v16, v30
  v_mul_f32 v8, v31, v8
  v_mul_f32 v9, v31, v9
  v_mul_f32 v10, v31, v10
  v_mul_f32 v11, v31, v11
  v_mul_f32 v12, v31, v12
  v_mul_f32 v13, v31, v13
  v_mul_f32 v14, v31, v14
  v_mul_f32 v15, v31, v15
  v_mul_f32 v17, v31, v17
  v_cvt_pk_bf16_f32 v22, v18, 0
  v_cvt_pk_bf16_f32 v26, 0, v18
  v_cvt_pk_bf16_f32 v23, v19, 0
  v_cvt_pk_bf16_f32 v27, 0, v19
  v_cvt_pk_bf16_f32 v24, v20, 0
  v_cvt_pk_bf16_f32 v28, 0, v20
  v_cvt_pk_bf16_f32 v25, v21, 0
  v_cvt_pk_bf16_f32 v29, 0, v21
  v_add_f32 v30, v18, v19
  v_add_f32 v31, v20, v21
  v_add_f32 v17, v17, v30
  v_add_f32 v17, v17, v31
  s_waitcnt vmcnt(11)
  v_dot2c_f32_bf16 v8, v80, v22
  v_dot2c_f32_bf16 v9, v80, v26
  v_dot2c_f32_bf16 v10, v81, v22
  v_dot2c_f32_bf16 v11, v81, v26
  v_dot2c_f32_bf16 v12, v82, v22
  v_dot2c_f32_bf16 v13, v82, v26
  v_dot2c_f32_bf16 v14, v83, v22
  v_dot2c_f32_bf16 v15, v83, v26
  s_waitcnt vmcnt(10)
  v_dot2c_f32_bf16 v8, v84, v23
  v_dot2c_f32_bf16 v9, v84, v27
  v_dot2c_f32_bf16 v10, v85, v23
  v_dot2c_f32_bf16 v11, v85, v27
  v_dot2c_f32_bf16 v12, v86, v23
  v_dot2c_f32_bf16 v13, v86, v27
  v_dot2c_f32_bf16 v14, v87, v23
  v_dot2c_f32_bf16 v15, v87, v27
  s_waitcnt vmcnt(9)
  v_dot2c_f32_bf16 v8, v88, v24
  v_dot2c_f32_bf16 v9, v88, v28
  v_dot2c_f32_bf16 v10, v89, v24
  v_dot2c_f32_bf16 v11, v89, v28
  v_dot2c_f32_bf16 v12, v90, v24
  v_dot2c_f32_bf16 v13, v90, v28
  v_dot2c_f32_bf16 v14, v91, v24
  v_dot2c_f32_bf16 v15, v91, v28
  s_waitcnt vmcnt(8)
  v_dot2c_f32_bf16 v8, v92, v25
  v_dot2c_f32_bf16 v9, v92, v29
  v_dot2c_f32_bf16 v10, v93, v25
  v_dot2c_f32_bf16 v11, v93, v29
  v_dot2c_f32_bf16 v12, v94, v25
  v_dot2c_f32_bf16 v13, v94, v29
  v_dot2c_f32_bf16 v14, v95, v25
  v_dot2c_f32_bf16 v15, v95, v29
L_mid1:
  s_waitcnt vmcnt(7)
  v_subrev_u32 v189, 4, v0
  ds_read_b32 v176, v189
  v_dot2_f32_bf16 v18, v32, v4, 0
  v_dot2_f32_bf16 v18, v33, v5, v18
  v_dot2_f32_bf16 v18, v34, v6, v18
  v_dot2_f32_bf16 v18, v35, v7, v18
  s_waitcnt lgkmcnt(0)
  v_readfirstlane_b32 s6, v176
  s_nop 3
  s_cmp_lt_u32 s6, -2
  s_cbranch_scc1 L_ramp0
  s_waitcnt vmcnt(6)
  v_dot2_f32_bf16 v19, v36, v4, 0
  v_dot2_f32_bf16 v19, v37, v5, v19
  v_dot2_f32_bf16 v19, v38, v6, v19
  v_dot2_f32_bf16 v19, v39, v7, v19
  s_waitcnt vmcnt(5)
  v_dot2_f32_bf16 v20, v40, v4, 0
  v_dot2_f32_bf16 v20, v41, v5, v20
  v_dot2_f32_bf16 v20, v42, v6, v20
  v_dot2_f32_bf16 v20, v43, v7, v20
  s_waitcnt vmcnt(4)
  v_dot2_f32_bf16 v21, v44, v4, 0
  v_dot2_f32_bf16 v21, v45, v5, v21
  v_dot2_f32_bf16 v21, v46, v6, v21
  v_dot2_f32_bf16 v21, v47, v7, v21
  v_add_f32_dpp v18, v18, v18 quad_perm:[1,0,3,2] row_mask:0xf bank_mask:0xf
  v_add_f32_dpp v19, v19, v19 quad_perm:[1,0,3,2] row_mask:0xf bank_mask:0xf
  v_add_f32_dpp v20, v20, v20 quad_perm:[1,0,3,2] row_mask:0xf bank_mask:0xf
  v_add_f32_dpp v21, v21, v21 quad_perm:[1,0,3,2] row_mask:0xf bank_mask:0xf
  v_add_f32_dpp v18, v18, v18 quad_perm:[2,3,0,1] row_mask:0xf bank_mask:0xf
  v_add_f32_dpp v19, v19, v19 quad_perm:[2,3,0,1] row_mask:0xf bank_mask:0xf
  v_add_f32_dpp v20, v20, v20 quad_perm:[2,3,0,1] row_mask:0xf bank_mask:0xf
  v_add_f32_dpp v21, v21, v21 quad_perm:[2,3,0,1] row_mask:0xf bank_mask:0xf
  v_add_f32_dpp v18, v18, v18 row_half_mirror row_mask:0xf bank_mask:0xf
  v_add_f32_dpp v19, v19, v19 row_half_mirror row_mask:0xf bank_mask:0xf
  v_add_f32_dpp v20, v20, v20 row_half_mirror row_mask:0xf bank_mask:0xf
  v_add_f32_dpp v21, v21, v21 row_half_mirror row_mask:0xf bank_mask:0xf
  v_add_f32_dpp v18, v18, v18 row_mirror row_mask:0xf bank_mask:0xf
  v_add_f32_dpp v19, v19, v19 row_mirror row_mask:0xf bank_mask:0xf
  v_add_f32_dpp v20, v20, v20 row_mirror row_mask:0xf bank_mask:0xf
  v_add_f32_dpp v21, v21, v21 row_mirror row_mask:0xf bank_mask:0xf
  v_max3_f32 v30, v18, v19, v16
  v_max3_f32 v30, v20, v21, v30
  v_sub_f32 v31, v16, v30
  v_mul_f32 v16, s16, v30
  v_mul_f32 v31, s16, v31
  v_fma_f32 v18, v18, s16, -v16
  v_fma_f32 v19, v19, s16, -v16
  v_fma_f32 v20, v20, s16, -v16
  v_fma_f32 v21, v21, s16, -v16
  v_exp_f32 v31, v31
  v_exp_f32 v18, v18
  v_exp_f32 v19, v19
  v_exp_f32 v20, v20
  v_exp_f32 v21, v21
  v_mov_b32 v16, v30
  v_mul_f32 v8, v31, v8
  v_mul_f32 v9, v31, v9
  v_mul_f32 v10, v31, v10
  v_mul_f32 v11, v31, v11
  v_mul_f32 v12, v31, v12
  v_mul_f32 v13, v31, v13
  v_mul_f32 v14, v31, v14
  v_mul_f32 v15, v31, v15
  v_mul_f32 v17, v31, v17
  v_cvt_pk_bf16_f32 v22, v18, 0
  v_cvt_pk_bf16_f32 v26, 0, v18
  v_cvt_pk_bf16_f32 v23, v19, 0
  v_cvt_pk_bf16_f32 v27, 0, v19
  v_cvt_pk_bf16_f32 v24, v20, 0
  v_cvt_pk_bf16_f32 v28, 0, v20
  v_cvt_pk_bf16_f32 v25, v21, 0
  v_cvt_pk_bf16_f32 v29, 0, v21
  v_add_f32 v30, v18, v19
  v_add_f32 v31, v20, v21
  v_add_f32 v17, v17, v30
  v_add_f32 v17, v17, v31
  s_waitcnt vmcnt(3)
  v_dot2c_f32_bf16 v8, v48, v22
  v_dot2c_f32_bf16 v9, v48, v26
  v_dot2c_f32_bf16 v10, v49, v22
  v_dot2c_f32_bf16 v11, v49, v26
  v_dot2c_f32_bf16 v12, v50, v22
  v_dot2c_f32_bf16 v13, v50, v26
  v_dot2c_f32_bf16 v14, v51, v22
  v_dot2c_f32_bf16 v15, v51, v26
  s_waitcnt vmcnt(2)
  v_dot2c_f32_bf16 v8, v52, v23
  v_dot2c_f32_bf16 v9, v52, v27
  v_dot2c_f32_bf16 v10, v53, v23
  v_dot2c_f32_bf16 v11, v53, v27
  v_dot2c_f32_bf16 v12, v54, v23
  v_dot2c_f32_bf16 v13, v54, v27
  v_dot2c_f32_bf16 v14, v55, v23
  v_dot2c_f32_bf16 v15, v55, v27
  s_waitcnt vmcnt(1)
  v_dot2c_f32_bf16 v8, v56, v24
  v_dot2c_f32_bf16 v9, v56, v28
  v_dot2c_f32_bf16 v10, v57, v24
  v_dot2c_f32_bf16 v11, v57, v28
  v_dot2c_f32_bf16 v12, v58, v24
  v_dot2c_f32_bf16 v13, v58, v28
  v_dot2c_f32_bf16 v14, v59, v24
  v_dot2c_f32_bf16 v15, v59, v28
  s_waitcnt vmcnt(0)
  v_subrev_u32 v189, 4, v0
  ds_read_b32 v176, v189
  v_dot2c_f32_bf16 v8, v60, v25
  v_dot2c_f32_bf16 v9, v60, v29
  v_dot2c_f32_bf16 v10, v61, v25
  v_dot2c_f32_bf16 v11, v61, v29
  v_dot2c_f32_bf16 v12, v62, v25
  v_dot2c_f32_bf16 v13, v62, v29
  v_dot2c_f32_bf16 v14, v63, v25
  v_dot2c_f32_bf16 v15, v63, v29
  s_cmp_eq_u32 s6, -2
  s_cbranch_scc1 L_t1
L_dry1:
  s_waitcnt lgkmcnt(0)
  v_readfirstlane_b32 s6, v176
  s_sub_u32 s7, s7, 1
  s_cbranch_scc1 L_t1
  s_nop 0
  s_cmp_eq_u32 s6, -2
  s_cbranch_scc1 L_t1
  ds_read_b32 v176, v189
  s_cmp_eq_u32 s6, -1
  s_cbranch_scc1 L_dry1
  ds_write_b32 v177, v0
  v_add_u32 v0, 4, v0
  buffer_load_dwordx4 v[32:35], v1, s[8:11], s6 offen offset:0 nt
  buffer_load_dwordx4 v[36:39], v1, s[8:11], s6 offen offset:1024 nt
  buffer_load_dwordx4 v[40:43], v1, s[8:11], s6 offen offset:2048 nt
  buffer_load_dwordx4 v[44:47], v1, s[8:11], s6 offen offset:3072 nt
  buffer_load_dwordx4 v[48:51], v1, s[12:15], s6 offen offset:0 nt
  buffer_load_dwordx4 v[52:55], v1, s[12:15], s6 offen offset:1024 nt
  buffer_load_dwordx4 v[56:59], v1, s[12:15], s6 offen offset:2048 nt
  buffer_load_dwordx4 v[60:63], v1, s[12:15], s6 offen offset:3072 nt
  s_branch L_mid1
L_slowe0:
  s_waitcnt vmcnt(14)
  v_dot2_f32_bf16 v19, v36, v4, 0
  v_dot2_f32_bf16 v19, v37, v5, v19
  v_dot2_f32_bf16 v19, v38, v6, v19
  v_dot2_f32_bf16 v19, v39, v7, v19
  s_waitcnt vmcnt(13)
  v_dot2_f32_bf16 v20, v40, v4, 0
  v_dot2_f32_bf16 v20, v41, v5, v20
  v_dot2_f32_bf16 v20, v42, v6, v20
  v_dot2_f32_bf16 v20, v43, v7, v20
  s_waitcnt vmcnt(12)
  v_dot2_f32_bf16 v21, v44, v4, 0
  v_dot2_f32_bf16 v21, v45, v5, v21
  v_dot2_f32_bf16 v21, v46, v6, v21
  v_dot2_f32_bf16 v21, v47, v7, v21
  v_add_f32_dpp v18, v18, v18 quad_perm:[1,0,3,2] row_mask:0xf bank_mask:0xf
  v_add_f32_dpp v19, v19, v19 quad_perm:[1,0,3,2] row_mask:0xf bank_mask:0xf
  v_add_f32_dpp v20, v20, v20 quad_perm:[1,0,3,2] row_mask:0xf bank_mask:0xf
  v_add_f32_dpp v21, v21, v21 quad_perm:[1,0,3,2] row_mask:0xf bank_mask:0xf
  v_add_f32_dpp v18, v18, v18 quad_perm:[2,3,0,1] row_mask:0xf bank_mask:0xf
  v_add_f32_dpp v19, v19, v19 quad_perm:[2,3,0,1] row_mask:0xf bank_mask:0xf
  v_add_f32_dpp v20, v20, v20 quad_perm:[2,3,0,1] row_mask:0xf bank_mask:0xf
  v_add_f32_dpp v21, v21, v21 quad_perm:[2,3,0,1] row_mask:0xf bank_mask:0xf
  v_add_f32_dpp v18, v18, v18 row_half_mirror row_mask:0xf bank_mask:0xf
  v_add_f32_dpp v19, v19, v19 row_half_mirror row_mask:0xf bank_mask:0xf
  v_add_f32_dpp v20, v20, v20 row_half_mirror row_mask:0xf bank_mask:0xf
  v_add_f32_dpp v21, v21, v21 row_half_mirror row_mask:0xf bank_mask:0xf
  v_add_f32_dpp v18, v18, v18 row_mirror row_mask:0xf bank_mask:0xf
  v_add_f32_dpp v19, v19, v19 row_mirror row_mask:0xf bank_mask:0xf
  v_add_f32_dpp v20, v20, v20 row_mirror row_mask:0xf bank_mask:0xf
  v_add_f32_dpp v21, v21, v21 row_mirror row_mask:0xf bank_mask:0xf
  v_max3_f32 v30, v18, v19, v16
  v_max3_f32 v30, v20, v21, v30
  v_sub_f32 v31, v16, v30
  v_mul_f32 v16, s16, v30
  v_mul_f32 v31, s16, v31
  v_fma_f32 v18, v18, s16, -v16
  v_fma_f32 v19, v19, s16, -v16
  v_fma_f32 v20, v20, s16, -v16
  v_fma_f32 v21, v21, s16, -v16
  v_exp_f32 v31, v31
  v_exp_f32 v18, v18
  v_exp_f32 v19, v19
  v_exp_f32 v20, v20
  v_exp_f32 v21, v21
  v_mov_b32 v16, v30
  v_mul_f32 v8, v31, v8
  v_mul_f32 v9, v31, v9
  v_mul_f32 v10, v31, v10
  v_mul_f32 v11, v31, v11
  v_mul_f32 v12, v31, v12
  v_mul_f32 v13, v31, v13
  v_mul_f32 v14, v31, v14
  v_mul_f32 v15, v31, v15
  v_mul_f32 v17, v31, v17
  v_cvt_pk_bf16_f32 v22, v18, 0
  v_cvt_pk_bf16_f32 v26, 0, v18
  v_cvt_pk_bf16_f32 v23, v19, 0
  v_cvt_pk_bf16_f32 v27, 0, v19
  v_cvt_pk_bf16_f32 v24, v20, 0
  v_cvt_pk_bf16_f32 v28, 0, v20
  v_cvt_pk_bf16_f32 v25, v21, 0
  v_cvt_pk_bf16_f32 v29, 0, v21
  v_add_f32 v30, v18, v19
  v_add_f32 v31, v20, v21
  v_add_f32 v17, v17, v30
  v_add_f32 v17, v17, v31
  s_waitcnt vmcnt(11)
  v_dot2c_f32_bf16 v8, v48, v22
  v_dot2c_f32_bf16 v9, v48, v26
  v_dot2c_f32_bf16 v10, v49, v22
  v_dot2c_f32_bf16 v11, v49, v26
  v_dot2c_f32_bf16 v12, v50, v22
  v_dot2c_f32_bf16 v13, v50, v26
  v_dot2c_f32_bf16 v14, v51, v22
  v_dot2c_f32_bf16 v15, v51, v26
  s_waitcnt vmcnt(10)
  v_dot2c_f32_bf16 v8, v52, v23
  v_dot2c_f32_bf16 v9, v52, v27
  v_dot2c_f32_bf16 v10, v53, v23
  v_dot2c_f32_bf16 v11, v53, v27
  v_dot2c_f32_bf16 v12, v54, v23
  v_dot2c_f32_bf16 v13, v54, v27
  v_dot2c_f32_bf16 v14, v55, v23
  v_dot2c_f32_bf16 v15, v55, v27
  s_waitcnt vmcnt(9)
  v_dot2c_f32_bf16 v8, v56, v24
  v_dot2c_f32_bf16 v9, v56, v28
  v_dot2c_f32_bf16 v10, v57, v24
  v_dot2c_f32_bf16 v11, v57, v28
  v_dot2c_f32_bf16 v12, v58, v24
  v_dot2c_f32_bf16 v13, v58, v28
  v_dot2c_f32_bf16 v14, v59, v24
  v_dot2c_f32_bf16 v15, v59, v28
  s_waitcnt vmcnt(8)
  v_dot2c_f32_bf16 v8, v60, v25
  v_dot2c_f32_bf16 v9, v60, v29
  v_dot2c_f32_bf16 v10, v61, v25
  v_dot2c_f32_bf16 v11, v61, v29
  v_dot2c_f32_bf16 v12, v62, v25
  v_dot2c_f32_bf16 v13, v62, v29
  v_dot2c_f32_bf16 v14, v63, v25
  v_dot2c_f32_bf16 v15, v63, v29
L_mid0:
  s_waitcnt vmcnt(7)
  v_subrev_u32 v189, 4, v0
  ds_read_b32 v176, v189
  v_dot2_f32_bf16 v18, v64, v4, 0
  v_dot2_f32_bf16 v18, v65, v5, v18
  v_dot2_f32_bf16 v18, v66, v6, v18
  v_dot2_f32_bf16 v18, v67, v7, v18
  s_waitcnt lgkmcnt(0)
  v_readfirstlane_b32 s6, v176
  s_nop 3
  s_cmp_lt_u32 s6, -2
  s_cbranch_scc1 L_ramp1
  s_waitcnt vmcnt(6)
  v_dot2_f32_bf16 v19, v68, v4, 0
  v_dot2_f32_bf16 v19, v69, v5, v19
  v_dot2_f32_bf16 v19, v70, v6, v19
  v_dot2_f32_bf16 v19, v71, v7, v19
  s_waitcnt vmcnt(5)
  v_dot2_f32_bf16 v20, v72, v4, 0
  v_dot2_f32_bf16 v20, v73, v5, v20
  v_dot2_f32_bf16 v20, v74, v6, v20
  v_dot2_f32_bf16 v20, v75, v7, v20
  s_waitcnt vmcnt(4)
  v_dot2_f32_bf16 v21, v76, v4, 0
  v_dot2_f32_bf16 v21, v77, v5, v21
  v_dot2_f32_bf16 v21, v78, v6, v21
  v_dot2_f32_bf16 v21, v79, v7, v21
  v_add_f32_dpp v18, v18, v18 quad_perm:[1,0,3,2] row_mask:0xf bank_mask:0xf
  v_add_f32_dpp v19, v19, v19 quad_perm:[1,0,3,2] row_mask:0xf bank_mask:0xf
  v_add_f32_dpp v20, v20, v20 quad_perm:[1,0,3,2] row_mask:0xf bank_mask:0xf
  v_add_f32_dpp v21, v21, v21 quad_perm:[1,0,3,2] row_mask:0xf bank_mask:0xf
  v_add_f32_dpp v18, v18, v18 quad_perm:[2,3,0,1] row_mask:0xf bank_mask:0xf
  v_add_f32_dpp v19, v19, v19 quad_perm:[2,3,0,1] row_mask:0xf bank_mask:0xf
  v_add_f32_dpp v20, v20, v20 quad_perm:[2,3,0,1] row_mask:0xf bank_mask:0xf
  v_add_f32_dpp v21, v21, v21 quad_perm:[2,3,0,1] row_mask:0xf bank_mask:0xf
  v_add_f32_dpp v18, v18, v18 row_half_mirror row_mask:0xf bank_mask:0xf
  v_add_f32_dpp v19, v19, v19 row_half_mirror row_mask:0xf bank_mask:0xf
  v_add_f32_dpp v20, v20, v20 row_half_mirror row_mask:0xf bank_mask:0xf
  v_add_f32_dpp v21, v21, v21 row_half_mirror row_mask:0xf bank_mask:0xf
  v_add_f32_dpp v18, v18, v18 row_mirror row_mask:0xf bank_mask:0xf
  v_add_f32_dpp v19, v19, v19 row_mirror row_mask:0xf bank_mask:0xf
  v_add_f32_dpp v20, v20, v20 row_mirror row_mask:0xf bank_mask:0xf
  v_add_f32_dpp v21, v21, v21 row_mirror row_mask:0xf bank_mask:0xf
  v_max3_f32 v30, v18, v19, v16
  v_max3_f32 v30, v20, v21, v30
  v_sub_f32 v31, v16, v30
  v_mul_f32 v16, s16, v30
  v_mul_f32 v31, s16, v31
  v_fma_f32 v18, v18, s16, -v16
  v_fma_f32 v19, v19, s16, -v16
  v_fma_f32 v20, v20, s16, -v16
  v_fma_f32 v21, v21, s16, -v16
  v_exp_f32 v31, v31
  v_exp_f32 v18, v18
  v_exp_f32 v19, v19
  v_exp_f32 v20, v20
  v_exp_f32 v21, v21
  v_mov_b32 v16, v30
  v_mul_f32 v8, v31, v8
  v_mul_f32 v9, v31, v9
  v_mul_f32 v10, v31, v10
  v_mul_f32 v11, v31, v11
  v_mul_f32 v12, v31, v12
  v_mul_f32 v13, v31, v13
  v_mul_f32 v14, v31, v14
  v_mul_f32 v15, v31, v15
  v_mul_f32 v17, v31, v17
  v_cvt_pk_bf16_f32 v22, v18, 0
  v_cvt_pk_bf16_f32 v26, 0, v18
  v_cvt_pk_bf16_f32 v23, v19, 0
  v_cvt_pk_bf16_f32 v27, 0, v19
  v_cvt_pk_bf16_f32 v24, v20, 0
  v_cvt_pk_bf16_f32 v28, 0, v20
  v_cvt_pk_bf16_f32 v25, v21, 0
  v_cvt_pk_bf16_f32 v29, 0, v21
  v_add_f32 v30, v18, v19
  v_add_f32 v31, v20, v21
  v_add_f32 v17, v17, v30
  v_add_f32 v17, v17, v31
  s_waitcnt vmcnt(3)
  v_dot2c_f32_bf16 v8, v80, v22
  v_dot2c_f32_bf16 v9, v80, v26
  v_dot2c_f32_bf16 v10, v81, v22
  v_dot2c_f32_bf16 v11, v81, v26
  v_dot2c_f32_bf16 v12, v82, v22
  v_dot2c_f32_bf16 v13, v82, v26
  v_dot2c_f32_bf16 v14, v83, v22
  v_dot2c_f32_bf16 v15, v83, v26
  s_waitcnt vmcnt(2)
  v_dot2c_f32_bf16 v8, v84, v23
  v_dot2c_f32_bf16 v9, v84, v27
  v_dot2c_f32_bf16 v10, v85, v23
  v_dot2c_f32_bf16 v11, v85, v27
  v_dot2c_f32_bf16 v12, v86, v23
  v_dot2c_f32_bf16 v13, v86, v27
  v_dot2c_f32_bf16 v14, v87, v23
  v_dot2c_f32_bf16 v15, v87, v27
  s_waitcnt vmcnt(1)
  v_dot2c_f32_bf16 v8, v88, v24
  v_dot2c_f32_bf16 v9, v88, v28
  v_dot2c_f32_bf16 v10, v89, v24
  v_dot2c_f32_bf16 v11, v89, v28
  v_dot2c_f32_bf16 v12, v90, v24
  v_dot2c_f32_bf16 v13, v90, v28
  v_dot2c_f32_bf16 v14, v91, v24
  v_dot2c_f32_bf16 v15, v91, v28
  s_waitcnt vmcnt(0)
  v_subrev_u32 v189, 4, v0
  ds_read_b32 v176, v189
  v_dot2c_f32_bf16 v8, v92, v25
  v_dot2c_f32_bf16 v9, v92, v29
  v_dot2c_f32_bf16 v10, v93, v25
  v_dot2c_f32_bf16 v11, v93, v29
  v_dot2c_f32_bf16 v12, v94, v25
  v_dot2c_f32_bf16 v13, v94, v29
  v_dot2c_f32_bf16 v14, v95, v25
  v_dot2c_f32_bf16 v15, v95, v29
  s_cmp_eq_u32 s6, -2
  s_cbranch_scc1 L_t1
L_dry0:
  s_waitcnt lgkmcnt(0)
  v_readfirstlane_b32 s6, v176
  s_sub_u32 s7, s7, 1
  s_cbranch_scc1 L_t1
  s_nop 0
  s_cmp_eq_u32 s6, -2
  s_cbranch_scc1 L_t1
  ds_read_b32 v176, v189
  s_cmp_eq_u32 s6, -1
  s_cbranch_scc1 L_dry0
  ds_write_b32 v177, v0
  v_add_u32 v0, 4, v0
  buffer_load_dwordx4 v[64:67], v1, s[8:11], s6 offen offset:0 nt
  buffer_load_dwordx4 v[68:71], v1, s[8:11], s6 offen offset:1024 nt
  buffer_load_dwordx4 v[72:75], v1, s[8:11], s6 offen offset:2048 nt
  buffer_load_dwordx4 v[76:79], v1, s[8:11], s6 offen offset:3072 nt
  buffer_load_dwordx4 v[80:83], v1, s[12:15], s6 offen offset:0 nt
  buffer_load_dwordx4 v[84:87], v1, s[12:15], s6 offen offset:1024 nt
  buffer_load_dwordx4 v[88:91], v1, s[12:15], s6 offen offset:2048 nt
  buffer_load_dwordx4 v[92:95], v1, s[12:15], s6 offen offset:3072 nt
  s_branch L_mid0
L_t1:
  ds_write_b32 v181, v16 offset:2816
  ds_write_b32 v181, v17 offset:2880
  s_nop 0
  ds_write_b128 v180, v[8:11] offset:4096
  ds_write_b128 v180, v[12:15] offset:4112
  global_load_dwordx4 v[160:163], v179, s[44:45] offset:0 nt
  global_load_dwordx4 v[164:167], v179, s[44:45] offset:1024 nt
  global_load_dwordx4 v[168:171], v179, s[44:45] offset:2048 nt
  global_load_dwordx4 v[172:175], v179, s[44:45] offset:3072 nt
  s_waitcnt lgkmcnt(0)
  s_barrier
  ds_read_b128 v[32:35], v183 offset:2816
  ds_read_b128 v[36:39], v183 offset:2832
  ds_read_b128 v[40:43], v183 offset:2880
  ds_read_b128 v[44:47], v183 offset:2896
  ds_read_b32 v48, v182 offset:4096
  ds_read_b32 v49, v182 offset:4608
  ds_read_b32 v50, v182 offset:5120
  ds_read_b32 v51, v182 offset:5632
  ds_read_b32 v52, v182 offset:6144
  ds_read_b32 v53, v182 offset:6656
  ds_read_b32 v54, v182 offset:7168
  ds_read_b32 v55, v182 offset:7680
  s_mov_b32 s7, 1048576
  s_waitcnt lgkmcnt(10)
  v_max3_f32 v22, v32, v33, v34
  v_max3_f32 v23, v35, v36, v37
  v_max3_f32 v22, v38, v39, v22
  v_max_f32 v22, v22, v23
  v_mov_b32 v23, v22
  s_nop 1
  v_permlane32_swap_b32 v22, v23
  v_max_f32 v22, v22, v23
  v_mul_f32 v22, s16, v22
  v_bfi_b32 v22, 63, 0, v22
  v_fma_f32 v32, v32, s16, -v22
  v_fma_f32 v33, v33, s16, -v22
  v_fma_f32 v34, v34, s16, -v22
  v_fma_f32 v35, v35, s16, -v22
  v_fma_f32 v36, v36, s16, -v22
  v_fma_f32 v37, v37, s16, -v22
  v_fma_f32 v38, v38, s16, -v22
  v_fma_f32 v39, v39, s16, -v22
  v_exp_f32 v32, v32
  v_exp_f32 v33, v33
  v_exp_f32 v34, v34
  v_exp_f32 v35, v35
  v_exp_f32 v36, v36
  v_exp_f32 v37, v37
  v_exp_f32 v38, v38
  v_exp_f32 v39, v39
  s_waitcnt lgkmcnt(0)
  v_mul_f32 v24, v32, v48
  v_mul_f32 v25, v32, v40
  v_mul_f32 v26, v33, v49
  v_mul_f32 v27, v33, v41
  v_fmac_f32 v24, v34, v50
  v_fmac_f32 v25, v34, v42
  v_fmac_f32 v26, v35, v51
  v_fmac_f32 v27, v35, v43
  v_fmac_f32 v24, v36, v52
  v_fmac_f32 v25, v36, v44
  v_fmac_f32 v26, v37, v53
  v_fmac_f32 v27, v37, v45
  v_fmac_f32 v24, v38, v54
  v_fmac_f32 v25, v38, v46
  v_fmac_f32 v26, v39, v55
  v_fmac_f32 v27, v39, v47
  v_add_f32 v24, v24, v26
  v_add_f32 v25, v25, v27
  s_nop 1
  v_permlane32_swap_b32 v24, v25
  v_add_f32 v23, v24, v25
  v_cndmask_b32 v23, v23, v22, s[24:25]
  v_bfi_b32 v23, 63, s17, v23
  global_store_dword v184, v23, s[56:57] sc1
  v_mov_b32 v30, 2944
  ds_read_b32 v30, v30
  v_mov_b32 v8, 0
  v_mov_b32 v9, 0
  v_mov_b32 v10, 0
  v_mov_b32 v11, 0
  v_mov_b32 v12, 0
  v_mov_b32 v13, 0
  v_mov_b32 v14, 0
  v_mov_b32 v15, 0
L_t2poll:
  global_load_dwordx4 v[32:35], v185, s[56:57] sc1
  global_load_dwordx2 v[36:37], v185, s[56:57] offset:128 sc1
  s_sub_u32 s7, s7, 1
  s_waitcnt vmcnt(0)
  s_cbranch_scc1 L_t2go
  v_xor_b32 v32, s17, v32
  v_xor_b32 v33, s17, v33
  v_xor_b32 v34, s17, v34
  v_xor_b32 v35, s17, v35
  v_xor_b32 v36, s17, v36
  v_xor_b32 v37, s17, v37
  v_or3_b32 v22, v32, v33, v34
  v_or3_b32 v23, v35, v36, v37
  v_or_b32 v22, v22, v23
  v_and_b32 v22, 63, v22
  v_cmp_ne_u32 vcc, 0, v22
  s_cbranch_vccnz L_t2poll
L_t2go:
  v_max_f32_dpp v22, v36, v36 quad_perm:[1,0,3,2] row_mask:0xf bank_mask:0xf
  s_nop 1
  v_max_f32_dpp v22, v22, v22 quad_perm:[2,3,0,1] row_mask:0xf bank_mask:0xf
  s_nop 1
  v_max_f32_dpp v22, v22, v22 row_half_mirror row_mask:0xf bank_mask:0xf
  s_nop 1
  v_sub_f32 v22, v36, v22
  v_exp_f32 v22, v22
  s_nop 0
  v_mul_f32 v37, v22, v37
  v_mul_f32 v32, v22, v32
  v_mul_f32 v33, v22, v33
  v_mul_f32 v34, v22, v34
  v_mul_f32 v35, v22, v35
  v_add_f32_dpp v37, v37, v37 quad_perm:[1,0,3,2] row_mask:0xf bank_mask:0xf
  v_add_f32_dpp v32, v32, v32 quad_perm:[1,0,3,2] row_mask:0xf bank_mask:0xf
  v_add_f32_dpp v33, v33, v33 quad_perm:[1,0,3,2] row_mask:0xf bank_mask:0xf
  v_add_f32_dpp v34, v34, v34 quad_perm:[1,0,3,2] row_mask:0xf bank_mask:0xf
  v_add_f32_dpp v35, v35, v35 quad_perm:[1,0,3,2] row_mask:0xf bank_mask:0xf
  v_add_f32_dpp v37, v37, v37 quad_perm:[2,3,0,1] row_mask:0xf bank_mask:0xf
  v_add_f32_dpp v32, v32, v32 quad_perm:[2,3,0,1] row_mask:0xf bank_mask:0xf
  v_add_f32_dpp v33, v33, v33 quad_perm:[2,3,0,1] row_mask:0xf bank_mask:0xf
  v_add_f32_dpp v34, v34, v34 quad_perm:[2,3,0,1] row_mask:0xf bank_mask:0xf
  v_add_f32_dpp v35, v35, v35 quad_perm:[2,3,0,1] row_mask:0xf bank_mask:0xf
  v_add_f32_dpp v37, v37, v37 row_half_mirror row_mask:0xf bank_mask:0xf
  v_add_f32_dpp v32, v32, v32 row_half_mirror row_mask:0xf bank_mask:0xf
  v_add_f32_dpp v33, v33, v33 row_half_mirror row_mask:0xf bank_mask:0xf
  v_add_f32_dpp v34, v34, v34 row_half_mirror row_mask:0xf bank_mask:0xf
  v_add_f32_dpp v35, v35, v35 row_half_mirror row_mask:0xf bank_mask:0xf
  v_rcp_f32 v22, v37
  s_nop 0
  v_mul_f32 v32, v22, v32
  v_mul_f32 v33, v22, v33
  v_mul_f32 v34, v22, v34
  v_mul_f32 v35, v22, v35
  v_cvt_pk_bf16_f32 v22, v32, 0
  v_cvt_pk_bf16_f32 v26, 0, v32
  v_cvt_pk_bf16_f32 v23, v33, 0
  v_cvt_pk_bf16_f32 v27, 0, v33
  v_cvt_pk_bf16_f32 v24, v34, 0
  v_cvt_pk_bf16_f32 v28, 0, v34
  v_cvt_pk_bf16_f32 v25, v35, 0
  v_cvt_pk_bf16_f32 v29, 0, v35
  v_dot2c_f32_bf16 v8, v160, v22
  v_dot2c_f32_bf16 v9, v160, v26
  v_dot2c_f32_bf16 v10, v161, v22
  v_dot2c_f32_bf16 v11, v161, v26
  v_dot2c_f32_bf16 v12, v162, v22
  v_dot2c_f32_bf16 v13, v162, v26
  v_dot2c_f32_bf16 v14, v163, v22
  v_dot2c_f32_bf16 v15, v163, v26
  v_dot2c_f32_bf16 v8, v164, v23
  v_dot2c_f32_bf16 v9, v164, v27
  v_dot2c_f32_bf16 v10, v165, v23
  v_dot2c_f32_bf16 v11, v165, v27
  v_dot2c_f32_bf16 v12, v166, v23
  v_dot2c_f32_bf16 v13, v166, v27
  v_dot2c_f32_bf16 v14, v167, v23
  v_dot2c_f32_bf16 v15, v167, v27
  v_dot2c_f32_bf16 v8, v168, v24
  v_dot2c_f32_bf16 v9, v168, v28
  v_dot2c_f32_bf16 v10, v169, v24
  v_dot2c_f32_bf16 v11, v169, v28
  v_dot2c_f32_bf16 v12, v170, v24
  v_dot2c_f32_bf16 v13, v170, v28
  v_dot2c_f32_bf16 v14, v171, v24
  v_dot2c_f32_bf16 v15, v171, v28
  v_dot2c_f32_bf16 v8, v172, v25
  v_dot2c_f32_bf16 v9, v172, v29
  v_dot2c_f32_bf16 v10, v173, v25
  v_dot2c_f32_bf16 v11, v173, v29
  v_dot2c_f32_bf16 v12, v174, v25
  v_dot2c_f32_bf16 v13, v174, v29
  v_dot2c_f32_bf16 v14, v175, v25
  v_dot2c_f32_bf16 v15, v175, v29
  v_permlane32_swap_b32 v8, v9
  v_permlane32_swap_b32 v10, v11
  s_nop 0
  v_permlane32_swap_b32 v12, v13
  v_permlane32_swap_b32 v14, v15
  v_add_f32 v8, v8, v9
  v_add_f32 v10, v10, v11
  v_add_f32 v12, v12, v13
  v_add_f32 v14, v14, v15
  s_nop 0
  v_permlane16_swap_b32 v8, v10
  v_permlane16_swap_b32 v12, v14
  v_add_f32 v8, v8, v10
  v_add_f32 v12, v12, v14
  s_nop 0
  v_add_f32_dpp v8, v8, v8 row_ror:8 row_mask:0xf bank_mask:0xf
  v_add_f32_dpp v12, v12, v12 row_ror:8 row_mask:0xf bank_mask:0xf
  v_cndmask_b32 v8, v8, v12, s[26:27]
  ds_write_b32 v186, v8 offset:3072
  s_waitcnt lgkmcnt(0)
  s_barrier
  s_cmp_lg_u32 s3, 0
  s_cbranch_scc1 L_end
  ds_read_b32 v8, v188 offset:3072
  ds_read_b32 v9, v188 offset:3328
  ds_read_b32 v10, v188 offset:3584
  ds_read_b32 v11, v188 offset:3840
  v_cmp_eq_u32 vcc, 1, v30
  s_waitcnt lgkmcnt(0)
  v_add_f32 v8, v8, v9
  v_add_f32 v10, v10, v11
  v_add_f32 v8, v8, v10
  v_bfi_b32 v8, 63, s17, v8
  s_cbranch_vccnz L_sploc
  global_store_dword v187, v8, s[56:57] sc1
  s_endpgm
L_sploc:
  global_store_dword v187, v8, s[56:57]
  s_endpgm
L_helper:
  s_setprio 3
  v_lshlrev_b32 v3, 3, v2
  v_lshrrev_b32 v8, 4, v2
  v_lshlrev_b32 v9, 17, v8
  v_and_b32 v10, 15, v2
  v_lshl_add_u32 v9, v10, 4, v9
  s_lshl_b32 s58, s5, 19
  s_lshl_b32 s59, s4, 8
  s_add_u32 s58, s58, s59
  v_add_u32 v9, s58, v9
  s_mul_i32 s63, s5, 1664
  s_add_u32 s63, s63, s34
  s_add_u32 s63, s63, 18432
  v_mov_b32 v15, s63
  v_mov_b32 v16, 0
  s_mul_i32 s62, s4, 43
  s_add_u32 s63, s62, 43
  s_lshr_b32 s62, s62, 3
  s_lshr_b32 s63, s63, 3
  s_sub_u32 s63, s63, s62
  v_lshrrev_b32 v190, 3, v2
  v_and_b32 v191, 7, v2
  s_sub_u32 s58, s63, 1
  v_min_u32 v11, s58, v191
  v_add_u32 v11, s62, v11
  v_lshlrev_b32 v11, 4, v11
  v_mul_u32_u24 v12, 22016, v190
  v_add_u32 v11, v12, v11
  s_mul_i32 s58, s5, 176128
  v_add_u32 v11, s58, v11
  v_mul_u32_u24 v12, 6, v190
  s_lshl_b32 s58, s62, 3
  v_add_u32 v12, s58, v12
  v_lshlrev_b32 v13, 4, v191
  s_lshl_b32 s58, s5, 7
  v_add_u32 v13, s58, v13
  s_waitcnt lgkmcnt(0)
  global_load_dwordx4 v[4:7], v1, s[36:37]
  global_load_dwordx4 v[32:35], v9, s[42:43] nt
  v_add_u32 v9, 0x2000, v9
  global_load_dwordx4 v[36:39], v9, s[42:43] nt
  v_add_u32 v9, 0x2000, v9
  global_load_dwordx4 v[40:43], v9, s[42:43] nt
  v_add_u32 v9, 0x2000, v9
  global_load_dwordx4 v[44:47], v9, s[42:43] nt
  v_add_u32 v9, 0x2000, v9
  global_load_dwordx4 v[48:51], v9, s[42:43] nt
  v_add_u32 v9, 0x2000, v9
  global_load_dwordx4 v[52:55], v9, s[42:43] nt
  v_add_u32 v9, 0x2000, v9
  global_load_dwordx4 v[56:59], v9, s[42:43] nt
  v_add_u32 v9, 0x2000, v9
  global_load_dwordx4 v[60:63], v9, s[42:43] nt
  v_add_u32 v9, 0x2000, v9
  global_load_dwordx4 v[64:67], v9, s[42:43] nt
  v_add_u32 v9, 0x2000, v9
  global_load_dwordx4 v[68:71], v9, s[42:43] nt
  v_add_u32 v9, 0x2000, v9
  global_load_dwordx4 v[72:75], v9, s[42:43] nt
  v_add_u32 v9, 0x2000, v9
  global_load_dwordx4 v[76:79], v9, s[42:43] nt
  v_add_u32 v9, 0x2000, v9
  global_load_dwordx4 v[80:83], v9, s[42:43] nt
  v_add_u32 v9, 0x2000, v9
  global_load_dwordx4 v[84:87], v9, s[42:43] nt
  v_add_u32 v9, 0x2000, v9
  global_load_dwordx4 v[88:91], v9, s[42:43] nt
  v_add_u32 v9, 0x2000, v9
  global_load_dwordx4 v[92:95], v9, s[42:43] nt
  global_store_dword v15, v16, s[56:57] sc1
  global_load_dwordx4 v[132:135], v11, s[48:49]
  v_add_u32 v11, 2752, v11
  global_load_dwordx4 v[136:139], v11, s[48:49]
  v_add_u32 v11, 2752, v11
  global_load_dwordx4 v[140:143], v11, s[48:49]
  v_add_u32 v11, 2752, v11
  global_load_dwordx4 v[144:147], v11, s[48:49]
  v_add_u32 v11, 2752, v11
  global_load_dwordx4 v[148:151], v11, s[48:49]
  v_add_u32 v11, 2752, v11
  global_load_dwordx4 v[152:155], v11, s[48:49]
  v_add_u32 v11, 2752, v11
  global_load_dwordx4 v[156:159], v11, s[48:49]
  v_add_u32 v11, 2752, v11
  global_load_dwordx4 v[160:163], v11, s[48:49]
  v_add_u32 v14, 0, v12
  v_min_u32 v14, 1375, v14
  v_lshl_add_u32 v14, v14, 10, v13
  global_load_dwordx4 v[164:167], v14, s[50:51] nt
  v_add_u32 v14, 1, v12
  v_min_u32 v14, 1375, v14
  v_lshl_add_u32 v14, v14, 10, v13
  global_load_dwordx4 v[168:171], v14, s[50:51] nt
  v_add_u32 v14, 2, v12
  v_min_u32 v14, 1375, v14
  v_lshl_add_u32 v14, v14, 10, v13
  global_load_dwordx4 v[172:175], v14, s[50:51] nt
  v_add_u32 v14, 3, v12
  v_min_u32 v14, 1375, v14
  v_lshl_add_u32 v14, v14, 10, v13
  global_load_dwordx4 v[176:179], v14, s[50:51] nt
  v_add_u32 v14, 4, v12
  v_min_u32 v14, 1375, v14
  v_lshl_add_u32 v14, v14, 10, v13
  global_load_dwordx4 v[180:183], v14, s[50:51] nt
  v_add_u32 v14, 5, v12
  v_min_u32 v14, 1375, v14
  v_lshl_add_u32 v14, v14, 10, v13
  global_load_dwordx4 v[184:187], v14, s[50:51] nt
  s_load_dword s17, s[56:57], 36608
  v_add_u32 v11, s34, v3
  s_lshl_b32 s58, s5, 9
  v_add_u32 v12, s58, v11
  v_mov_b32 v20, s32
  v_bfe_u32 v21, v2, 0, 1
  v_lshl_add_u32 v20, v21, 21, v20
  v_bfe_u32 v21, v2, 1, 4
  v_lshl_add_u32 v20, v21, 17, v20
  v_bfe_u32 v21, v2, 5, 1
  v_lshl_add_u32 v20, v21, 22, v20
  v_cmp_gt_u32 vcc, 61, v2
  v_lshlrev_b32 v21, 2, v2
  v_mov_b32 v17, -1
  v_mov_b32 v18, 2952
  v_cndmask_b32 v20, -1, v20, vcc
  ds_write_b32 v21, v20 offset:12288
  ds_write_b32 v21, v17 offset:12544
  ds_write_b32 v21, v16 offset:256
  ds_write_b32 v18, v16
  s_memrealtime s[66:67]
  s_add_u32 s58, s34, 12288
  v_add_u32 v193, s58, v21
  s_lshl_b32 s58, s5, 8
  v_add_u32 v192, s58, v193
  v_lshlrev_b32 v194, 5, v191
  v_and_b32 v14, 8, v2
  v_lshl_add_u32 v194, v14, 1, v194
  v_bfe_u32 v14, v2, 4, 1
  v_lshl_add_u32 v194, v14, 3, v194
  v_lshrrev_b32 v14, 5, v2
  v_lshl_add_u32 v194, v14, 2, v194
  v_bfe_u32 v13, v2, 4, 1
  v_lshlrev_b32 v13, 2, v13
  v_lshl_add_u32 v13, v10, 4, v13
  v_lshl_add_u32 v13, v14, 1, v13
  v_lshlrev_b32 v18, 5, v2
  v_lshlrev_b32 v19, 6, v8
  s_lshl_b32 s58, s5, 8
  v_add_u32 v19, s58, v19
  v_lshlrev_b32 v17, 5, v190
  v_add_u32 v17, s58, v17
  s_mov_b32 s26, 0xff00ff00
  s_mov_b32 s27, 0xff00ff00
  s_getreg_b32 s19, hwreg(HW_REG_XCC_ID)
  s_and_b32 s19, s19, 15
  s_and_b32 s60, s4, 7
  s_lshr_b32 s61, s4, 3
  s_lshl_b32 s19, s19, 6
  s_waitcnt vmcnt(31)
  v_lshlrev_b32 v20, 16, v4
  v_and_b32 v21, 0xffff0000, v4
  v_lshlrev_b32 v22, 16, v5
  v_and_b32 v23, 0xffff0000, v5
  v_lshlrev_b32 v24, 16, v6
  v_and_b32 v25, 0xffff0000, v6
  v_lshlrev_b32 v26, 16, v7
  v_and_b32 v27, 0xffff0000, v7
  v_add_f32 v28, v20, v21
  v_add_f32 v29, v22, v23
  v_add_f32 v30, v24, v25
  v_add_f32 v31, v26, v27
  v_add_f32 v28, v28, v29
  v_add_f32 v30, v30, v31
  v_add_f32 v28, v28, v30
  s_nop 1
  v_add_f32_dpp v28, v28, v28 quad_perm:[1,0,3,2] row_mask:0xf bank_mask:0xf
  s_nop 1
  v_add_f32_dpp v28, v28, v28 quad_perm:[2,3,0,1] row_mask:0xf bank_mask:0xf
  s_nop 1
  v_add_f32_dpp v28, v28, v28 row_half_mirror row_mask:0xf bank_mask:0xf
  s_nop 1
  v_add_f32_dpp v28, v28, v28 row_mirror row_mask:0xf bank_mask:0xf
  v_mov_b32 v29, v28
  s_nop 1
  v_permlane16_swap_b32 v28, v29
  v_add_f32 v28, v28, v29
  v_mov_b32 v29, v28
  s_nop 1
  v_permlane32_swap_b32 v28, v29
  v_add_f32 v28, v28, v29
  v_mul_f32 v28, 0x3b000000, v28
  v_sub_f32 v29, v20, v28
  v_sub_f32 v31, v21, v28
  v_mul_f32 v30, v29, v29
  v_mul_f32 v4, v31, v31
  v_sub_f32 v29, v22, v28
  v_sub_f32 v31, v23, v28
  v_fmac_f32 v30, v29, v29
  v_fmac_f32 v4, v31, v31
  v_sub_f32 v29, v24, v28
  v_sub_f32 v31, v25, v28
  v_fmac_f32 v30, v29, v29
  v_fmac_f32 v4, v31, v31
  v_sub_f32 v29, v26, v28
  v_sub_f32 v31, v27, v28
  v_fmac_f32 v30, v29, v29
  v_fmac_f32 v4, v31, v31
  v_add_f32 v30, v30, v4
  s_nop 1
  v_add_f32_dpp v30, v30, v30 quad_perm:[1,0,3,2] row_mask:0xf bank_mask:0xf
  s_nop 1
  v_add_f32_dpp v30, v30, v30 quad_perm:[2,3,0,1] row_mask:0xf bank_mask:0xf
  s_nop 1
  v_add_f32_dpp v30, v30, v30 row_half_mirror row_mask:0xf bank_mask:0xf
  s_nop 1
  v_add_f32_dpp v30, v30, v30 row_mirror row_mask:0xf bank_mask:0xf
  v_mov_b32 v29, v30
  s_nop 1
  v_permlane16_swap_b32 v30, v29
  v_add_f32 v30, v30, v29
  v_mov_b32 v29, v30
  s_nop 1
  v_permlane32_swap_b32 v30, v29
  v_add_f32 v30, v30, v29
  v_mul_f32 v30, 0x3b000000, v30
  v_cvt_pk_bf16_f32 v28, 0, v28
  v_cvt_pk_bf16_f32 v30, 0, v30
  v_add_f32 v30, 0x3727c5ac, v30
  v_cvt_pk_bf16_f32 v30, 0, v30
  v_sqrt_f32 v30, v30
  v_sub_f32 v20, v20, v28
  v_sub_f32 v21, v21, v28
  v_sub_f32 v22, v22, v28
  v_sub_f32 v23, v23, v28
  v_sub_f32 v24, v24, v28
  v_sub_f32 v25, v25, v28
  v_sub_f32 v26, v26, v28
  v_sub_f32 v27, v27, v28
  v_cvt_pk_bf16_f32 v30, 0, v30
  v_rcp_f32 v31, v30
  v_cvt_pk_bf16_f32 v20, 0, v20
  v_cvt_pk_bf16_f32 v21, 0, v21
  v_cvt_pk_bf16_f32 v22, 0, v22
  v_cvt_pk_bf16_f32 v23, 0, v23
  v_cvt_pk_bf16_f32 v24, 0, v24
  v_cvt_pk_bf16_f32 v25, 0, v25
  v_cvt_pk_bf16_f32 v26, 0, v26
  v_cvt_pk_bf16_f32 v27, 0, v27
  v_mul_f32 v4, v20, v31
  v_mul_f32 v5, v21, v31
  v_fma_f32 v6, -v4, v30, v20
  v_fma_f32 v7, -v5, v30, v21
  v_fma_f32 v4, v6, v31, v4
  v_fma_f32 v5, v7, v31, v5
  v_cvt_pk_bf16_f32 v20, 0, v4
  v_cvt_pk_bf16_f32 v21, 0, v5
  v_mul_f32 v4, v22, v31
  v_mul_f32 v5, v23, v31
  v_fma_f32 v6, -v4, v30, v22
  v_fma_f32 v7, -v5, v30, v23
  v_fma_f32 v4, v6, v31, v4
  v_fma_f32 v5, v7, v31, v5
  v_cvt_pk_bf16_f32 v22, 0, v4
  v_cvt_pk_bf16_f32 v23, 0, v5
  v_mul_f32 v4, v24, v31
  v_mul_f32 v5, v25, v31
  v_fma_f32 v6, -v4, v30, v24
  v_fma_f32 v7, -v5, v30, v25
  v_fma_f32 v4, v6, v31, v4
  v_fma_f32 v5, v7, v31, v5
  v_cvt_pk_bf16_f32 v24, 0, v4
  v_cvt_pk_bf16_f32 v25, 0, v5
  v_mul_f32 v4, v26, v31
  v_mul_f32 v5, v27, v31
  v_fma_f32 v6, -v4, v30, v26
  v_fma_f32 v7, -v5, v30, v27
  v_fma_f32 v4, v6, v31, v4
  v_fma_f32 v5, v7, v31, v5
  v_cvt_pk_bf16_f32 v26, 0, v4
  v_cvt_pk_bf16_f32 v27, 0, v5
  ds_write_b128 v18, v[20:23] offset:512
  ds_write_b128 v18, v[24:27] offset:528
  ds_read_b128 v[112:115], v19 offset:512
  ds_read_b128 v[116:119], v19 offset:528
  ds_read_b128 v[120:123], v19 offset:544
  ds_read_b128 v[124:127], v19 offset:560
  ds_read_b128 v[96:99], v17 offset:512
  ds_read_b128 v[100:103], v17 offset:528
  v_mov_b32 v20, 0
  v_mov_b32 v21, 0
  v_mov_b32 v22, 0
  v_mov_b32 v23, 0
  v_mov_b32 v24, 0
  v_mov_b32 v25, 0
  v_mov_b32 v26, 0
  v_mov_b32 v27, 0
  s_waitcnt lgkmcnt(0)
  s_add_u32 s18, s17, 1
  s_and_b32 s17, s18, 63
  s_or_b32 s19, s19, s17
  s_lshl_b32 s66, s66, 6
  s_add_u32 s66, s66, 536870912
  v_mov_b32 v30, s66
  v_mov_b32 v31, 0
  v_mov_b32 v29, 2952
  ds_write_b64 v29, v[30:31]
  v_lshrrev_b32 v128, 16, v112
  s_waitcnt vmcnt(30)
  v_dot2c_f32_bf16 v21, v32, v112
  v_dot2c_f32_bf16 v23, v33, v112
  v_dot2c_f32_bf16 v25, v34, v112
  v_dot2c_f32_bf16 v27, v35, v112
  v_dot2c_f32_bf16 v20, v32, v128
  v_dot2c_f32_bf16 v22, v33, v128
  v_dot2c_f32_bf16 v24, v34, v128
  v_dot2c_f32_bf16 v26, v35, v128
  v_lshrrev_b32 v129, 16, v113
  s_waitcnt vmcnt(29)
  v_dot2c_f32_bf16 v21, v36, v113
  v_dot2c_f32_bf16 v23, v37, v113
  v_dot2c_f32_bf16 v25, v38, v113
  v_dot2c_f32_bf16 v27, v39, v113
  v_dot2c_f32_bf16 v20, v36, v129
  v_dot2c_f32_bf16 v22, v37, v129
  v_dot2c_f32_bf16 v24, v38, v129
  v_dot2c_f32_bf16 v26, v39, v129
  v_lshrrev_b32 v128, 16, v114
  s_waitcnt vmcnt(28)
  v_dot2c_f32_bf16 v21, v40, v114
  v_dot2c_f32_bf16 v23, v41, v114
  v_dot2c_f32_bf16 v25, v42, v114
  v_dot2c_f32_bf16 v27, v43, v114
  v_dot2c_f32_bf16 v20, v40, v128
  v_dot2c_f32_bf16 v22, v41, v128
  v_dot2c_f32_bf16 v24, v42, v128
  v_dot2c_f32_bf16 v26, v43, v128
  v_lshrrev_b32 v129, 16, v115
  s_waitcnt vmcnt(27)
  v_dot2c_f32_bf16 v21, v44, v115
  v_dot2c_f32_bf16 v23, v45, v115
  v_dot2c_f32_bf16 v25, v46, v115
  v_dot2c_f32_bf16 v27, v47, v115
  v_dot2c_f32_bf16 v20, v44, v129
  v_dot2c_f32_bf16 v22, v45, v129
  v_dot2c_f32_bf16 v24, v46, v129
  v_dot2c_f32_bf16 v26, v47, v129
  v_lshrrev_b32 v128, 16, v116
  s_waitcnt vmcnt(26)
  v_dot2c_f32_bf16 v21, v48, v116
  v_dot2c_f32_bf16 v23, v49, v116
  v_dot2c_f32_bf16 v25, v50, v116
  v_dot2c_f32_bf16 v27, v51, v116
  v_dot2c_f32_bf16 v20, v48, v128
  v_dot2c_f32_bf16 v22, v49, v128
  v_dot2c_f32_bf16 v24, v50, v128
  v_dot2c_f32_bf16 v26, v51, v128
  v_lshrrev_b32 v129, 16, v117
  s_waitcnt vmcnt(25)
  v_dot2c_f32_bf16 v21, v52, v117
  v_dot2c_f32_bf16 v23, v53, v117
  v_dot2c_f32_bf16 v25, v54, v117
  v_dot2c_f32_bf16 v27, v55, v117
  v_dot2c_f32_bf16 v20, v52, v129
  v_dot2c_f32_bf16 v22, v53, v129
  v_dot2c_f32_bf16 v24, v54, v129
  v_dot2c_f32_bf16 v26, v55, v129
  v_lshrrev_b32 v128, 16, v118
  s_waitcnt vmcnt(24)
  v_dot2c_f32_bf16 v21, v56, v118
  v_dot2c_f32_bf16 v23, v57, v118
  v_dot2c_f32_bf16 v25, v58, v118
  v_dot2c_f32_bf16 v27, v59, v118
  v_dot2c_f32_bf16 v20, v56, v128
  v_dot2c_f32_bf16 v22, v57, v128
  v_dot2c_f32_bf16 v24, v58, v128
  v_dot2c_f32_bf16 v26, v59, v128
  v_lshrrev_b32 v129, 16, v119
  s_waitcnt vmcnt(23)
  v_dot2c_f32_bf16 v21, v60, v119
  v_dot2c_f32_bf16 v23, v61, v119
  v_dot2c_f32_bf16 v25, v62, v119
  v_dot2c_f32_bf16 v27, v63, v119
  v_dot2c_f32_bf16 v20, v60, v129
  v_dot2c_f32_bf16 v22, v61, v129
  v_dot2c_f32_bf16 v24, v62, v129
  v_dot2c_f32_bf16 v26, v63, v129
  v_lshrrev_b32 v128, 16, v120
  s_waitcnt vmcnt(22)
  v_dot2c_f32_bf16 v21, v64, v120
  v_dot2c_f32_bf16 v23, v65, v120
  v_dot2c_f32_bf16 v25, v66, v120
  v_dot2c_f32_bf16 v27, v67, v120
  v_dot2c_f32_bf16 v20, v64, v128
  v_dot2c_f32_bf16 v22, v65, v128
  v_dot2c_f32_bf16 v24, v66, v128
  v_dot2c_f32_bf16 v26, v67, v128
  v_lshrrev_b32 v129, 16, v121
  s_waitcnt vmcnt(21)
  v_dot2c_f32_bf16 v21, v68, v121
  v_dot2c_f32_bf16 v23, v69, v121
  v_dot2c_f32_bf16 v25, v70, v121
  v_dot2c_f32_bf16 v27, v71, v121
  v_dot2c_f32_bf16 v20, v68, v129
  v_dot2c_f32_bf16 v22, v69, v129
  v_dot2c_f32_bf16 v24, v70, v129
  v_dot2c_f32_bf16 v26, v71, v129
  v_lshrrev_b32 v128, 16, v122
  s_waitcnt vmcnt(20)
  v_dot2c_f32_bf16 v21, v72, v122
  v_dot2c_f32_bf16 v23, v73, v122
  v_dot2c_f32_bf16 v25, v74, v122
  v_dot2c_f32_bf16 v27, v75, v122
  v_dot2c_f32_bf16 v20, v72, v128
  v_dot2c_f32_bf16 v22, v73, v128
  v_dot2c_f32_bf16 v24, v74, v128
  v_dot2c_f32_bf16 v26, v75, v128
  v_lshrrev_b32 v129, 16, v123
  s_waitcnt vmcnt(19)
  v_dot2c_f32_bf16 v21, v76, v123
  v_dot2c_f32_bf16 v23, v77, v123
  v_dot2c_f32_bf16 v25, v78, v123
  v_dot2c_f32_bf16 v27, v79, v123
  v_dot2c_f32_bf16 v20, v76, v129
  v_dot2c_f32_bf16 v22, v77, v129
  v_dot2c_f32_bf16 v24, v78, v129
  v_dot2c_f32_bf16 v26, v79, v129
  v_lshrrev_b32 v128, 16, v124
  s_waitcnt vmcnt(18)
  v_dot2c_f32_bf16 v21, v80, v124
  v_dot2c_f32_bf16 v23, v81, v124
  v_dot2c_f32_bf16 v25, v82, v124
  v_dot2c_f32_bf16 v27, v83, v124
  v_dot2c_f32_bf16 v20, v80, v128
  v_dot2c_f32_bf16 v22, v81, v128
  v_dot2c_f32_bf16 v24, v82, v128
  v_dot2c_f32_bf16 v26, v83, v128
  v_lshrrev_b32 v129, 16, v125
  s_waitcnt vmcnt(17)
  v_dot2c_f32_bf16 v21, v84, v125
  v_dot2c_f32_bf16 v23, v85, v125
  v_dot2c_f32_bf16 v25, v86, v125
  v_dot2c_f32_bf16 v27, v87, v125
  v_dot2c_f32_bf16 v20, v84, v129
  v_dot2c_f32_bf16 v22, v85, v129
  v_dot2c_f32_bf16 v24, v86, v129
  v_dot2c_f32_bf16 v26, v87, v129
  v_lshrrev_b32 v128, 16, v126
  s_waitcnt vmcnt(16)
  v_dot2c_f32_bf16 v21, v88, v126
  v_dot2c_f32_bf16 v23, v89, v126
  v_dot2c_f32_bf16 v25, v90, v126
  v_dot2c_f32_bf16 v27, v91, v126
  v_dot2c_f32_bf16 v20, v88, v128
  v_dot2c_f32_bf16 v22, v89, v128
  v_dot2c_f32_bf16 v24, v90, v128
  v_dot2c_f32_bf16 v26, v91, v128
  v_lshrrev_b32 v129, 16, v127
  s_waitcnt vmcnt(15)
  v_dot2c_f32_bf16 v21, v92, v127
  v_dot2c_f32_bf16 v23, v93, v127
  v_dot2c_f32_bf16 v25, v94, v127
  v_dot2c_f32_bf16 v27, v95, v127
  v_dot2c_f32_bf16 v20, v92, v129
  v_dot2c_f32_bf16 v22, v93, v129
  v_dot2c_f32_bf16 v24, v94, v129
  v_dot2c_f32_bf16 v26, v95, v129
  s_nop 2
  v_permlane32_swap_b32 v20, v21
  v_permlane32_swap_b32 v22, v23
  v_permlane32_swap_b32 v24, v25
  v_permlane32_swap_b32 v26, v27
  v_add_f32 v20, v20, v21
  v_add_f32 v22, v22, v23
  v_add_f32 v24, v24, v25
  v_add_f32 v26, v26, v27
  s_nop 0
  v_permlane16_swap_b32 v20, v22
  v_permlane16_swap_b32 v24, v26
  v_add_f32 v20, v20, v22
  v_add_f32 v24, v24, v26
  v_bfi_b32 v28, 63, s17, v20
  v_bfi_b32 v29, 63, s17, v24
  s_waitcnt vmcnt(14)
  global_store_dwordx2 v12, v[28:29], s[56:57] sc1
  v_mov_b32 v20, 0
  v_mov_b32 v21, 0
  v_mov_b32 v22, 0
  v_mov_b32 v23, 0
  v_mov_b32 v24, 0
  v_mov_b32 v25, 0
  v_mov_b32 v26, 0
  v_mov_b32 v27, 0
  v_lshrrev_b32 v128, 16, v96
  s_waitcnt vmcnt(14)
  v_dot2c_f32_bf16 v21, v132, v96
  v_dot2c_f32_bf16 v23, v133, v96
  v_dot2c_f32_bf16 v25, v134, v96
  v_dot2c_f32_bf16 v27, v135, v96
  v_dot2c_f32_bf16 v20, v132, v128
  v_dot2c_f32_bf16 v22, v133, v128
  v_dot2c_f32_bf16 v24, v134, v128
  v_dot2c_f32_bf16 v26, v135, v128
  v_lshrrev_b32 v129, 16, v97
  s_waitcnt vmcnt(13)
  v_dot2c_f32_bf16 v21, v136, v97
  v_dot2c_f32_bf16 v23, v137, v97
  v_dot2c_f32_bf16 v25, v138, v97
  v_dot2c_f32_bf16 v27, v139, v97
  v_dot2c_f32_bf16 v20, v136, v129
  v_dot2c_f32_bf16 v22, v137, v129
  v_dot2c_f32_bf16 v24, v138, v129
  v_dot2c_f32_bf16 v26, v139, v129
  v_lshrrev_b32 v128, 16, v98
  s_waitcnt vmcnt(12)
  v_dot2c_f32_bf16 v21, v140, v98
  v_dot2c_f32_bf16 v23, v141, v98
  v_dot2c_f32_bf16 v25, v142, v98
  v_dot2c_f32_bf16 v27, v143, v98
  v_dot2c_f32_bf16 v20, v140, v128
  v_dot2c_f32_bf16 v22, v141, v128
  v_dot2c_f32_bf16 v24, v142, v128
  v_dot2c_f32_bf16 v26, v143, v128
  v_lshrrev_b32 v129, 16, v99
  s_waitcnt vmcnt(11)
  v_dot2c_f32_bf16 v21, v144, v99
  v_dot2c_f32_bf16 v23, v145, v99
  v_dot2c_f32_bf16 v25, v146, v99
  v_dot2c_f32_bf16 v27, v147, v99
  v_dot2c_f32_bf16 v20, v144, v129
  v_dot2c_f32_bf16 v22, v145, v129
  v_dot2c_f32_bf16 v24, v146, v129
  v_dot2c_f32_bf16 v26, v147, v129
  v_lshrrev_b32 v128, 16, v100
  s_waitcnt vmcnt(10)
  v_dot2c_f32_bf16 v21, v148, v100
  v_dot2c_f32_bf16 v23, v149, v100
  v_dot2c_f32_bf16 v25, v150, v100
  v_dot2c_f32_bf16 v27, v151, v100
  v_dot2c_f32_bf16 v20, v148, v128
  v_dot2c_f32_bf16 v22, v149, v128
  v_dot2c_f32_bf16 v24, v150, v128
  v_dot2c_f32_bf16 v26, v151, v128
  v_lshrrev_b32 v129, 16, v101
  s_waitcnt vmcnt(9)
  v_dot2c_f32_bf16 v21, v152, v101
  v_dot2c_f32_bf16 v23, v153, v101
  v_dot2c_f32_bf16 v25, v154, v101
  v_dot2c_f32_bf16 v27, v155, v101
  v_dot2c_f32_bf16 v20, v152, v129
  v_dot2c_f32_bf16 v22, v153, v129
  v_dot2c_f32_bf16 v24, v154, v129
  v_dot2c_f32_bf16 v26, v155, v129
  v_lshrrev_b32 v128, 16, v102
  s_waitcnt vmcnt(8)
  v_dot2c_f32_bf16 v21, v156, v102
  v_dot2c_f32_bf16 v23, v157, v102
  v_dot2c_f32_bf16 v25, v158, v102
  v_dot2c_f32_bf16 v27, v159, v102
  v_dot2c_f32_bf16 v20, v156, v128
  v_dot2c_f32_bf16 v22, v157, v128
  v_dot2c_f32_bf16 v24, v158, v128
  v_dot2c_f32_bf16 v26, v159, v128
  v_lshrrev_b32 v129, 16, v103
  s_waitcnt vmcnt(7)
  v_dot2c_f32_bf16 v21, v160, v103
  v_dot2c_f32_bf16 v23, v161, v103
  v_dot2c_f32_bf16 v25, v162, v103
  v_dot2c_f32_bf16 v27, v163, v103
  v_dot2c_f32_bf16 v20, v160, v129
  v_dot2c_f32_bf16 v22, v161, v129
  v_dot2c_f32_bf16 v24, v162, v129
  v_dot2c_f32_bf16 v26, v163, v129
  s_nop 2
  v_permlane32_swap_b32 v20, v21
  v_permlane32_swap_b32 v22, v23
  v_permlane32_swap_b32 v24, v25
  v_permlane32_swap_b32 v26, v27
  v_add_f32 v20, v20, v21
  v_add_f32 v22, v22, v23
  v_add_f32 v24, v24, v25
  v_add_f32 v26, v26, v27
  s_nop 0
  v_permlane16_swap_b32 v20, v22
  v_permlane16_swap_b32 v24, v26
  v_add_f32 v20, v20, v22
  v_add_f32 v24, v24, v26
  s_nop 0
  v_add_f32_dpp v20, v20, v20 row_ror:8 row_mask:0xf bank_mask:0xf
  v_add_f32_dpp v24, v24, v24 row_ror:8 row_mask:0xf bank_mask:0xf
  v_cndmask_b32 v20, v20, v24, s[26:27]
  v_bfi_b32 v30, 63, s17, v20
  global_store_dword v192, v30, s[56:57] sc1
  s_cmp_lg_u32 s60, s5
  s_cbranch_scc1 L_noxc
  s_add_u32 s58, s34, 32768
  v_and_b32 v4, 31, v2
  v_lshlrev_b32 v4, 2, v4
  v_add_u32 v4, s58, v4
  v_mov_b32 v5, s19
  global_store_dword v4, v5, s[56:57] sc1
L_noxc:
  s_mov_b32 s7, 1048576
L_qpoll:
  global_load_dwordx2 v[96:97], v11, s[56:57] offset:0 sc1
  global_load_dwordx2 v[98:99], v11, s[56:57] offset:512 sc1
  global_load_dwordx2 v[100:101], v11, s[56:57] offset:1024 sc1
  global_load_dwordx2 v[102:103], v11, s[56:57] offset:1536 sc1
  global_load_dwordx2 v[104:105], v11, s[56:57] offset:2048 sc1
  global_load_dwordx2 v[106:107], v11, s[56:57] offset:2560 sc1
  global_load_dwordx2 v[108:109], v11, s[56:57] offset:3072 sc1
  global_load_dwordx2 v[110:111], v11, s[56:57] offset:3584 sc1
  s_sub_u32 s7, s7, 1
  v_mov_b32 v31, 0
  s_cbranch_scc1 L_qgo
  s_waitcnt vmcnt(7)
  v_xor_b32 v96, s17, v96
  v_xor_b32 v97, s17, v97
  v_or3_b32 v31, v96, v97, v31
  s_waitcnt vmcnt(6)
  v_xor_b32 v98, s17, v98
  v_xor_b32 v99, s17, v99
  v_or3_b32 v31, v98, v99, v31
  s_waitcnt vmcnt(5)
  v_xor_b32 v100, s17, v100
  v_xor_b32 v101, s17, v101
  v_or3_b32 v31, v100, v101, v31
  s_waitcnt vmcnt(4)
  v_xor_b32 v102, s17, v102
  v_xor_b32 v103, s17, v103
  v_or3_b32 v31, v102, v103, v31
  s_waitcnt vmcnt(3)
  v_xor_b32 v104, s17, v104
  v_xor_b32 v105, s17, v105
  v_or3_b32 v31, v104, v105, v31
  s_waitcnt vmcnt(2)
  v_xor_b32 v106, s17, v106
  v_xor_b32 v107, s17, v107
  v_or3_b32 v31, v106, v107, v31
  s_waitcnt vmcnt(1)
  v_xor_b32 v108, s17, v108
  v_xor_b32 v109, s17, v109
  v_or3_b32 v31, v108, v109, v31
  s_waitcnt vmcnt(0)
  v_xor_b32 v110, s17, v110
  v_xor_b32 v111, s17, v111
  v_or3_b32 v31, v110, v111, v31
  v_and_b32 v31, 63, v31
  v_cmp_ne_u32 vcc, 0, v31
  s_cbranch_vccnz L_qpoll
L_qgo:
  s_waitcnt vmcnt(0)
  v_add_f32 v96, v96, v98
  v_add_f32 v97, v97, v99
  v_add_f32 v100, v100, v102
  v_add_f32 v101, v101, v103
  v_add_f32 v104, v104, v106
  v_add_f32 v105, v105, v107
  v_add_f32 v108, v108, v110
  v_add_f32 v109, v109, v111
  v_add_f32 v96, v96, v100
  v_add_f32 v97, v97, v101
  v_add_f32 v104, v104, v108
  v_add_f32 v105, v105, v109
  v_add_f32 v96, v96, v104
  v_add_f32 v97, v97, v105
  v_cvt_pk_bf16_f32 v31, v96, v97
  ds_write_b16 v13, v31 offset:0
  ds_write_b16_d16_hi v13, v31 offset:8
  s_waitcnt lgkmcnt(0)
  s_barrier
  s_setprio 0
  v_and_b32 v4, 3, v2
  v_lshlrev_b32 v4, 21, v4
  s_lshl_b32 s58, s4, 23
  v_add_u32 v4, s58, v4
  v_add_u32 v4, 0x1fff80, v4
  s_mov_b64 exec, 15
  global_load_dword v188, v4, s[38:39] nt
  global_load_dword v189, v4, s[40:41] nt
  s_mov_b64 exec, -1
  s_mov_b32 s7, 1048576
L_hpoll:
  global_load_dword v32, v193, s[56:57] offset:0 sc1
  global_load_dword v33, v193, s[56:57] offset:256 sc1
  global_load_dword v34, v193, s[56:57] offset:512 sc1
  global_load_dword v35, v193, s[56:57] offset:768 sc1
  global_load_dword v36, v193, s[56:57] offset:1024 sc1
  global_load_dword v37, v193, s[56:57] offset:1280 sc1
  global_load_dword v38, v193, s[56:57] offset:1536 sc1
  global_load_dword v39, v193, s[56:57] offset:1792 sc1
  s_sub_u32 s7, s7, 1
  s_waitcnt vmcnt(0)
  s_cbranch_scc1 L_hgo
  v_xor_b32 v32, s17, v32
  v_xor_b32 v33, s17, v33
  v_xor_b32 v34, s17, v34
  v_xor_b32 v35, s17, v35
  v_xor_b32 v36, s17, v36
  v_xor_b32 v37, s17, v37
  v_xor_b32 v38, s17, v38
  v_xor_b32 v39, s17, v39
  v_or3_b32 v4, v32, v33, v34
  v_or3_b32 v4, v35, v36, v4
  v_or3_b32 v4, v37, v38, v4
  v_or_b32 v4, v39, v4
  v_and_b32 v4, 63, v4
  v_cmp_ne_u32 vcc, 0, v4
  s_cbranch_vccnz L_hpoll
L_hgo:
  v_add_f32 v32, v32, v33
  v_add_f32 v34, v34, v35
  v_add_f32 v36, v36, v37
  v_add_f32 v38, v38, v39
  v_add_f32 v32, v32, v34
  v_add_f32 v36, v36, v38
  v_add_f32 v32, v32, v36
  v_cmp_gt_u32 vcc, s63, v191
  v_cvt_pk_bf16_f32 v4, 0, v32
  v_max_f32 v4, 0, v4
  v_cndmask_b32 v4, 0, v4, vcc
  ds_write_b32 v194, v4 offset:2560
  v_mul_u32_u24 v4, 24, v190
  ds_read_b64 v[112:113], v4 offset:2560
  ds_read_b64 v[114:115], v4 offset:2568
  ds_read_b64 v[116:117], v4 offset:2576
  v_mov_b32 v20, 0
  v_mov_b32 v21, 0
  v_mov_b32 v22, 0
  v_mov_b32 v23, 0
  v_mov_b32 v24, 0
  v_mov_b32 v25, 0
  v_mov_b32 v26, 0
  v_mov_b32 v27, 0
  s_lshl_b32 s58, s5, 8
  s_add_u32 s58, s58, s34
  s_add_u32 s58, s58, 16384
  v_add_u32 v194, s58, v194
  s_waitcnt lgkmcnt(0)
  v_lshrrev_b32 v128, 16, v112
  v_dot2c_f32_bf16 v21, v164, v112
  v_dot2c_f32_bf16 v23, v165, v112
  v_dot2c_f32_bf16 v25, v166, v112
  v_dot2c_f32_bf16 v27, v167, v112
  v_dot2c_f32_bf16 v20, v164, v128
  v_dot2c_f32_bf16 v22, v165, v128
  v_dot2c_f32_bf16 v24, v166, v128
  v_dot2c_f32_bf16 v26, v167, v128
  v_lshrrev_b32 v129, 16, v113
  v_dot2c_f32_bf16 v21, v168, v113
  v_dot2c_f32_bf16 v23, v169, v113
  v_dot2c_f32_bf16 v25, v170, v113
  v_dot2c_f32_bf16 v27, v171, v113
  v_dot2c_f32_bf16 v20, v168, v129
  v_dot2c_f32_bf16 v22, v169, v129
  v_dot2c_f32_bf16 v24, v170, v129
  v_dot2c_f32_bf16 v26, v171, v129
  v_lshrrev_b32 v128, 16, v114
  v_dot2c_f32_bf16 v21, v172, v114
  v_dot2c_f32_bf16 v23, v173, v114
  v_dot2c_f32_bf16 v25, v174, v114
  v_dot2c_f32_bf16 v27, v175, v114
  v_dot2c_f32_bf16 v20, v172, v128
  v_dot2c_f32_bf16 v22, v173, v128
  v_dot2c_f32_bf16 v24, v174, v128
  v_dot2c_f32_bf16 v26, v175, v128
  v_lshrrev_b32 v129, 16, v115
  v_dot2c_f32_bf16 v21, v176, v115
  v_dot2c_f32_bf16 v23, v177, v115
  v_dot2c_f32_bf16 v25, v178, v115
  v_dot2c_f32_bf16 v27, v179, v115
  v_dot2c_f32_bf16 v20, v176, v129
  v_dot2c_f32_bf16 v22, v177, v129
  v_dot2c_f32_bf16 v24, v178, v129
  v_dot2c_f32_bf16 v26, v179, v129
  v_lshrrev_b32 v128, 16, v116
  v_dot2c_f32_bf16 v21, v180, v116
  v_dot2c_f32_bf16 v23, v181, v116
  v_dot2c_f32_bf16 v25, v182, v116
  v_dot2c_f32_bf16 v27, v183, v116
  v_dot2c_f32_bf16 v20, v180, v128
  v_dot2c_f32_bf16 v22, v181, v128
  v_dot2c_f32_bf16 v24, v182, v128
  v_dot2c_f32_bf16 v26, v183, v128
  v_lshrrev_b32 v129, 16, v117
  v_dot2c_f32_bf16 v21, v184, v117
  v_dot2c_f32_bf16 v23, v185, v117
  v_dot2c_f32_bf16 v25, v186, v117
  v_dot2c_f32_bf16 v27, v187, v117
  v_dot2c_f32_bf16 v20, v184, v129
  v_dot2c_f32_bf16 v22, v185, v129
  v_dot2c_f32_bf16 v24, v186, v129
  v_dot2c_f32_bf16 v26, v187, v129
  s_nop 2
  v_permlane32_swap_b32 v20, v21
  v_permlane32_swap_b32 v22, v23
  v_permlane32_swap_b32 v24, v25
  v_permlane32_swap_b32 v26, v27
  v_add_f32 v20, v20, v21
  v_add_f32 v22, v22, v23
  v_add_f32 v24, v24, v25
  v_add_f32 v26, v26, v27
  s_nop 0
  v_permlane16_swap_b32 v20, v22
  v_permlane16_swap_b32 v24, v26
  v_add_f32 v20, v20, v22
  v_add_f32 v24, v24, v26
  s_nop 0
  v_add_f32_dpp v20, v20, v20 row_ror:8 row_mask:0xf bank_mask:0xf
  v_add_f32_dpp v24, v24, v24 row_ror:8 row_mask:0xf bank_mask:0xf
  v_cndmask_b32 v20, v20, v24, s[26:27]
  v_bfi_b32 v195, 63, s17, v20
  v_mov_b32 v6, 256
  v_mov_b32 v7, 2952
  v_mov_b32 v16, 0
  v_mov_b32 v17, 1
  s_mov_b32 s7, 4194304
  s_mov_b32 s65, -1
  s_mov_b32 s64, 12320
L_wx:
  ds_read_b32 v5, v6
  s_sub_u32 s7, s7, 1
  s_cbranch_scc1 L_wxgo
  s_waitcnt lgkmcnt(0)
  v_readfirstlane_b32 s58, v5
  s_nop 3
  s_cmp_lt_u32 s58, s65
  s_cbranch_scc1 L_wxon
  s_mov_b32 s65, -1
  ds_write_b32 v7, v16
L_wxon:
  s_cmp_ge_u32 s58, s64
  s_cbranch_scc1 L_wxgo
  s_sleep 4
  s_branch L_wx
L_wxgo:
  v_lshrrev_b32 v4, 4, v2
  v_mul_u32_u24 v4, 294912, v4
  v_and_b32 v5, 0x78, v3
  v_add_u32 v4, v5, v4
  s_mul_i32 s58, s5, 36864
  s_add_u32 s58, s58, 32768
  v_add_u32 v4, s58, v4
  global_load_dwordx2 v[24:25], v4, s[56:57] sc1
  s_lshl_b32 s58, s4, 17
  v_mov_b32 v4, s58
  v_mov_b32 v5, 0
  s_mov_b64 exec, 1
  global_load_dword v188, v4, s[44:45] nt
  global_load_dword v189, v5, s[52:53]
  s_mov_b64 exec, -1
  v_lshrrev_b32 v9, 2, v2
  v_mul_u32_u24 v9, 36864, v9
  v_and_b32 v11, 3, v2
  v_lshl_add_u32 v9, v11, 4, v9
  s_lshl_b32 s59, s61, 6
  s_lshl_b32 s58, s5, 8
  s_add_u32 s58, s58, s59
  v_add_u32 v9, s58, v9
  v_add_u32 v8, 16384, v9
  v_add_u32 v27, 606208, v9
  v_lshlrev_b32 v11, 3, v11
  v_bfe_u32 v12, v2, 4, 1
  v_lshl_add_u32 v11, v12, 2, v11
  v_lshrrev_b32 v12, 5, v2
  v_lshl_add_u32 v11, v12, 1, v11
  s_lshl_b32 s58, s5, 7
  s_lshr_b32 s59, s59, 1
  s_add_u32 s58, s58, s59
  v_add_u32 v11, s58, v11
  global_load_ushort v12, v11, s[36:37]
  s_waitcnt vmcnt(0)
  v_xor_b32 v24, s19, v24
  v_xor_b32 v25, s19, v25
  v_or_b32 v24, v24, v25
  v_cmp_ne_u32 vcc, 0, v24
  v_mov_b32 v4, 2944
  s_cmp_eq_u64 vcc, 0
  s_cselect_b32 s58, 1, 0
  v_mov_b32 v5, s58
  ds_write_b32 v4, v5
  s_cmp_eq_u32 s58, 1
  s_cbranch_scc1 L_bploc
  global_store_dword v194, v195, s[56:57] sc1
  s_branch L_bpdone
L_bploc:
  global_store_dword v194, v195, s[56:57]
L_bpdone:
  s_mov_b32 s64, 12324
  s_lshl_b32 s58, s4, 2
  s_add_u32 s58, s58, 33024
  v_mov_b32 v20, s58
  v_and_b32 v21, 31, v2
  v_lshlrev_b32 v21, 2, v21
  v_add_u32 v21, 33024, v21
L_ck:
L_wa:
  ds_read_b32 v5, v6
  s_sub_u32 s7, s7, 1
  s_cbranch_scc1 L_wago
  s_waitcnt lgkmcnt(0)
  v_readfirstlane_b32 s58, v5
  s_nop 3
  s_cmp_lt_u32 s58, s65
  s_cbranch_scc1 L_waon
  s_mov_b32 s65, -1
  ds_write_b32 v7, v16
L_waon:
  s_cmp_ge_u32 s58, s64
  s_cbranch_scc1 L_wago
  s_sleep 4
  s_branch L_wa
L_wago:
  s_memrealtime s[66:67]
  s_waitcnt lgkmcnt(0)
  s_lshl_b32 s62, s66, 6
  s_cmp_lg_u32 s60, s5
  s_cbranch_scc1 L_nopub
  s_or_b32 s58, s62, s17
  v_mov_b32 v22, s58
  s_mov_b64 exec, 1
  global_store_dword v20, v22, s[56:57] sc1
  s_mov_b64 exec, -1
L_nopub:
  s_add_u32 s64, s64, 12
L_wb:
  ds_read_b32 v5, v6
  s_sub_u32 s7, s7, 1
  s_cbranch_scc1 L_wbgo
  s_waitcnt lgkmcnt(0)
  v_readfirstlane_b32 s58, v5
  s_nop 3
  s_cmp_lt_u32 s58, s65
  s_cbranch_scc1 L_wbon
  s_mov_b32 s65, -1
  ds_write_b32 v7, v16
L_wbon:
  s_cmp_ge_u32 s58, s64
  s_cbranch_scc1 L_wbgo
  s_sleep 4
  s_branch L_wb
L_wbgo:
  global_load_dword v22, v21, s[56:57] sc1
  s_memrealtime s[66:67]
  v_add_u32 v20, 36864, v20
  v_add_u32 v21, 36864, v21
  s_waitcnt vmcnt(0) lgkmcnt(0)
  s_lshl_b32 s66, s66, 6
  v_xor_b32 v22, s17, v22
  v_sub_u32 v22, s66, v22
  v_alignbit_b32 v22, v22, v22, 6
  v_cmp_gt_u32 vcc, 0x1000, v22
  s_sub_u32 s66, s66, s62
  s_lshr_b32 s66, s66, 6
  v_cndmask_b32 v22, 0, v22, vcc
  v_subrev_u32 v22, s66, v22
  v_cvt_f32_i32 v22, v22
  s_nop 1
  v_add_f32_dpp v22, v22, v22 quad_perm:[1,0,3,2] row_mask:0xf bank_mask:0xf
  s_nop 1
  v_add_f32_dpp v22, v22, v22 quad_perm:[2,3,0,1] row_mask:0xf bank_mask:0xf
  s_nop 1
  v_add_f32_dpp v22, v22, v22 row_half_mirror row_mask:0xf bank_mask:0xf
  s_nop 1
  v_add_f32_dpp v22, v22, v22 row_mirror row_mask:0xf bank_mask:0xf
  v_mov_b32 v23, v22
  s_nop 1
  v_permlane16_swap_b32 v22, v23
  v_add_f32 v22, v22, v23
  v_mov_b32 v23, v22
  s_nop 1
  v_permlane32_swap_b32 v22, v23
  v_add_f32 v22, v22, v23
  v_cvt_i32_f32 v23, v22
  s_nop 0
  v_readfirstlane_b32 s59, v23
  s_nop 3
  s_sub_u32 s59, s62, s59
  s_sub_u32 s58, s59, s33
  s_mov_b32 s33, s59
  s_cmp_eq_u32 s64, 12336
  s_cbranch_scc1 L_nobo
  s_mul_hi_u32 s58, s58, 178956971
  s_sub_u32 s66, s64, 12
  s_mul_i32 s66, s66, s58
  s_sub_u32 s59, s59, s66
  s_add_u32 s59, s59, 4294965376
  v_mov_b32 v22, s59
  v_mov_b32 v23, s58
  ds_write_b64 v7, v[22:23]
L_nobo:
  s_add_u32 s64, s64, 12
  s_cmp_le_u32 s64, 12516
  s_cbranch_scc1 L_ck
L_claim:
  s_branch L_cl_done
  v_mov_b32 v4, 256
  s_mov_b32 s64, 61
  s_mov_b32 s7, 4194304
  s_mov_b32 s62, s5
  s_mov_b32 s28, 0
  s_add_u32 s63, s34, 18432
  v_and_b32 v15, 7, v2
  v_mul_u32_u24 v14, 1664, v15
  v_add_u32 v14, s63, v14
L_cl_poll:
  ds_read_b128 v[20:23], v4
  s_sub_u32 s7, s7, 1
  s_cbranch_scc1 L_cl_done
  s_waitcnt lgkmcnt(0)
  v_max3_u32 v5, v20, v21, v22
  v_max_u32 v5, v5, v23
  s_nop 0
  v_readfirstlane_b32 s58, v5
  s_nop 3
  s_max_u32 s58, s58, 12288
  s_sub_u32 s58, s58, 12280
  s_lshr_b32 s58, s58, 2
  s_cmp_gt_u32 s58, s64
  s_cbranch_scc1 L_cl_go
  s_sleep 2
  s_branch L_cl_poll
L_cl_go:
  s_sub_u32 s59, s58, s64
  v_mov_b32 v5, s59
  s_lshl_b64 s[66:67], 1, s62
  s_mov_b64 exec, s[66:67]
  global_atomic_add v6, v14, v5, s[56:57] sc0 sc1
  s_mov_b64 exec, 0xff
  s_add_u32 s28, s28, s59
  s_cmp_lt_u32 s28, 3
  s_cselect_b32 s29, 0, 1
  s_cbranch_scc1 L_cl_nold
  global_load_dword v10, v14, s[56:57] sc1
L_cl_nold:
  s_mov_b64 exec, -1
  v_add_u32 v16, s64, v2
  v_lshlrev_b32 v16, 2, v16
  s_lshl_b32 s68, s4, 23
  s_bfe_u32 s65, s62, 196608
  s_lshl_b32 s65, s65, 14
  s_add_u32 s68, s68, s65
  s_waitcnt vmcnt(0)
  v_readlane_b32 s63, v6, s62
  s_nop 3
  s_add_u32 s58, s63, s59
  s_min_u32 s69, s58, 3
  s_max_u32 s69, s69, s63
  s_sub_u32 s69, s69, s63
  v_add_u32 v6, s63, v2
  v_add_u32 v6, 61, v6
  v_mov_b32 v7, s68
  v_bfe_u32 v5, v6, 0, 1
  v_lshl_add_u32 v7, v5, 21, v7
  v_bfe_u32 v5, v6, 1, 4
  v_lshl_add_u32 v7, v5, 17, v7
  v_bfe_u32 v5, v6, 5, 1
  v_lshl_add_u32 v7, v5, 22, v7
  v_cmp_gt_u32 vcc, s69, v2
  s_cmp_eq_u32 s69, 0
  s_cbranch_scc1 L_cl_none
  s_mov_b64 exec, vcc
  ds_write_b32 v16, v7 offset:12288
  s_mov_b64 exec, -1
  s_add_u32 s64, s64, s69
L_cl_none:
  s_mov_b32 s28, s58
  s_cmp_lt_u32 s58, 3
  s_cselect_b32 s59, s62, -1
  s_cmp_eq_u32 s59, s5
  s_cbranch_scc1 L_cl_poll
  s_mov_b32 s28, 3
  s_cmp_eq_u32 s29, 1
  s_cbranch_scc1 L_cl_pick
  s_mov_b64 exec, 0xff
  global_load_dword v10, v14, s[56:57] sc1
  s_mov_b64 exec, -1
  s_waitcnt vmcnt(0)
L_cl_pick:
  v_mov_b32 v5, s58
  v_cndmask_b32 v10, v10, v5, s[66:67]
  v_lshl_add_u32 v10, v10, 3, v15
  s_nop 1
  v_min_u32_dpp v10, v10, v10 quad_perm:[1,0,3,2] row_mask:0xf bank_mask:0xf
  s_nop 1
  v_min_u32_dpp v10, v10, v10 quad_perm:[2,3,0,1] row_mask:0xf bank_mask:0xf
  s_nop 1
  v_min_u32_dpp v10, v10, v10 row_half_mirror row_mask:0xf bank_mask:0xf
  s_nop 1
  v_readfirstlane_b32 s58, v10
  s_nop 3
  s_and_b32 s62, s58, 7
  s_cmp_lt_u32 s58, 16
  s_cbranch_scc1 L_cl_poll
  s_lshl_b32 s58, s64, 2
  v_mov_b32 v16, s58
  v_mov_b32 v7, -2
  ds_write_b32 v16, v7 offset:12288
L_cl_done:
  s_waitcnt lgkmcnt(0)
  s_cmp_lg_u32 s60, s5
  s_cbranch_scc1 L_end
  s_barrier
  s_mov_b32 s7, 1048576
L_b_poll:
  global_load_dwordx4 v[32:35], v8, s[56:57] sc1
  global_load_dwordx4 v[36:39], v27, s[56:57] sc1
  s_sub_u32 s7, s7, 1
  v_mov_b32 v10, 0
  s_waitcnt vmcnt(0)
  s_cbranch_scc1 L_b_go
  v_xor_b32 v32, s17, v32
  v_xor_b32 v33, s17, v33
  v_xor_b32 v34, s17, v34
  v_xor_b32 v35, s17, v35
  v_or3_b32 v10, v32, v33, v10
  v_or3_b32 v10, v34, v35, v10
  v_xor_b32 v36, s17, v36
  v_xor_b32 v37, s17, v37
  v_xor_b32 v38, s17, v38
  v_xor_b32 v39, s17, v39
  v_or3_b32 v10, v36, v37, v10
  v_or3_b32 v10, v38, v39, v10
  v_and_b32 v10, 63, v10
  v_cmp_ne_u32 vcc, 0, v10
  s_cbranch_vccnz L_b_poll
L_b_go:
  v_add_f32 v32, v32, v36
  v_add_f32 v33, v33, v37
  v_add_f32 v34, v34, v38
  v_add_f32 v35, v35, v39
  s_nop 0
  v_permlane32_swap_b32 v32, v33
  v_permlane32_swap_b32 v34, v35
  v_add_f32 v32, v32, v33
  v_add_f32 v34, v34, v35
  s_nop 1
  v_permlane16_swap_b32 v32, v34
  v_add_f32 v20, v32, v34
  s_nop 1
  v_add_f32_dpp v20, v20, v20 row_ror:8 row_mask:0xf bank_mask:0xf
  s_nop 1
  v_add_f32_dpp v20, v20, v20 row_ror:4 row_mask:0xf bank_mask:0xf
  v_cvt_pk_bf16_f32 v20, 0, v20
  v_mul_f32 v21, 0xbfb8aa3b, v20
  v_exp_f32 v21, v21
  s_nop 0
  v_add_f32 v21, 1.0, v21
  v_rcp_f32 v22, v21
  s_nop 0
  v_mul_f32 v13, v20, v22
  v_cvt_pk_bf16_f32 v13, 0, v13
  v_lshlrev_b32 v12, 16, v12
  v_add_u32 v8, 14336, v9
  v_add_u32 v27, 604160, v9
  s_barrier
  s_mov_b32 s7, 1048576
L_s_poll:
  global_load_dwordx4 v[32:35], v8, s[56:57] sc1
  global_load_dwordx4 v[36:39], v27, s[56:57] sc1
  s_sub_u32 s7, s7, 1
  v_mov_b32 v10, 0
  s_waitcnt vmcnt(0)
  s_cbranch_scc1 L_s_go
  v_xor_b32 v32, s17, v32
  v_xor_b32 v33, s17, v33
  v_xor_b32 v34, s17, v34
  v_xor_b32 v35, s17, v35
  v_or3_b32 v10, v32, v33, v10
  v_or3_b32 v10, v34, v35, v10
  v_xor_b32 v36, s17, v36
  v_xor_b32 v37, s17, v37
  v_xor_b32 v38, s17, v38
  v_xor_b32 v39, s17, v39
  v_or3_b32 v10, v36, v37, v10
  v_or3_b32 v10, v38, v39, v10
  v_and_b32 v10, 63, v10
  v_cmp_ne_u32 vcc, 0, v10
  s_cbranch_vccnz L_s_poll
L_s_go:
  v_add_f32 v32, v32, v36
  v_add_f32 v33, v33, v37
  v_add_f32 v34, v34, v38
  v_add_f32 v35, v35, v39
  s_nop 0
  v_permlane32_swap_b32 v32, v33
  v_permlane32_swap_b32 v34, v35
  v_add_f32 v32, v32, v33
  v_add_f32 v34, v34, v35
  s_nop 1
  v_permlane16_swap_b32 v32, v34
  v_add_f32 v20, v32, v34
  s_nop 1
  v_add_f32_dpp v20, v20, v20 row_ror:8 row_mask:0xf bank_mask:0xf
  s_nop 1
  v_add_f32_dpp v20, v20, v20 row_ror:4 row_mask:0xf bank_mask:0xf
  v_cvt_pk_bf16_f32 v20, 0, v20
  v_mul_f32 v20, v20, v13
  v_cvt_pk_bf16_f32 v20, 0, v20
  v_add_f32 v20, v12, v20
  v_cvt_pk_bf16_f32 v20, v20, 0
  global_store_short v11, v20, s[52:53]
  s_cmp_lg_u32 s2, 0
  s_cbranch_scc1 L_end
  v_mov_b32 v4, 36608
  v_mov_b32 v5, s18
  global_store_dword v4, v5, s[56:57]
L_end:
  s_endpgm
L_codeend:
.section .rodata,"a"
.p2align 6
.amdhsa_kernel recurrent_scan__gqa_block_cached__dense_activation_relu__decode_kernel
  .amdhsa_next_free_vgpr 200
  .amdhsa_next_free_sgpr 96
  .amdhsa_accum_offset 200
  .amdhsa_group_segment_fixed_size 0
  .amdhsa_kernarg_size 88
  .amdhsa_user_sgpr_count 2
  .amdhsa_user_sgpr_kernarg_segment_ptr 1
  .amdhsa_system_sgpr_workgroup_id_x 1
  .amdhsa_float_denorm_mode_32 3
.end_amdhsa_kernel
```
